```python
import torch

def _softmax(x, axis=-1):
    return torch.softmax(x, dim=axis)
def _gelu(x):
    return torch.nn.functional.gelu(x, approximate="tanh")
def _silu(x):
    return torch.nn.functional.silu(x)
def _sigmoid(x):
    return torch.sigmoid(x)
def _layernorm(x, axis=-1, eps=1e-5):
    m = x.mean(dim=axis, keepdim=True)
    v = x.var(dim=axis, keepdim=True, unbiased=False)
    return (x - m) / torch.sqrt(v + eps)
def _scatter_add(tgt, idx, src, axis=0):
    return tgt.clone().index_add_(axis, idx, src)
def _segment_sum(src, seg, n):
    out = torch.zeros((n,) + src.shape[1:], dtype=src.dtype)
    return out.index_add_(0, seg, src)
def _pad(x, pw):
    flat = tuple(v for pair in reversed(pw) for v in pair)
    return torch.nn.functional.pad(x, flat)

kernel_name = 'concat_heads__gqa_block_cached__sliding_block_cached__decode'

def setup_inputs():

    _w = (lambda a: (lambda t: t.to(torch.bfloat16) if t.is_floating_point() else t)(torch.as_tensor(a)))
    def _A_setup():
        B, Sq, D = 1, 1, 576
        Hq, Hkv, Sk, Dh = 32, 16, 32768, 128
        assert Hq % Hkv == 0, (Hq, Hkv)
        return {
            "x": _w((lambda *s: torch.randn(*s, dtype=torch.bfloat16) * 0.8)(B, Sq, D)),
            "k_cache": _w((lambda *s: torch.randn(*s, dtype=torch.bfloat16) * 1.6)(B, Hkv, Sk, Dh)),
            "v_cache": _w((lambda *s: torch.randn(*s, dtype=torch.bfloat16) * 0.2)(B, Hkv, Sk, Dh)),
            "wq": _w((lambda *s: torch.randn(*s, dtype=torch.bfloat16) * 1.6)(D, Hq * Dh) * (D ** -0.5)),
            "wo": _w((lambda *s: torch.randn(*s, dtype=torch.bfloat16) * 0.2)(Hq * Dh, D) * ((Hq * Dh) ** -0.5)),
        }
    _A_in = _A_setup()

    def _B_setup():
        B, Sq, D = 1, 1, 576
        Hq, Hkv, Sk, Dh = 32, 16, 32768, 128
        assert Hq % Hkv == 0, (Hq, Hkv)
        return {
            "x": _w((lambda *s: torch.randn(*s, dtype=torch.bfloat16) * 0.8)(B, Sq, D)),
            "k_cache": _w((lambda *s: torch.randn(*s, dtype=torch.bfloat16) * 1.6)(B, Hkv, Sk, Dh)),
            "v_cache": _w((lambda *s: torch.randn(*s, dtype=torch.bfloat16) * 0.2)(B, Hkv, Sk, Dh)),
            "wq": _w((lambda *s: torch.randn(*s, dtype=torch.bfloat16) * 1.6)(D, Hq * Dh) * (D ** -0.5)),
            "wo": _w((lambda *s: torch.randn(*s, dtype=torch.bfloat16) * 0.2)(Hq * Dh, D) * ((Hq * Dh) ** -0.5)),
        }
    _B_in = _B_setup()

    return {
        "A_x": _A_in["x"],
        "A_k_cache": _A_in["k_cache"],
        "A_v_cache": _A_in["v_cache"],
        "A_wq": _A_in["wq"],
        "A_wo": _A_in["wo"],
        "B_x": _B_in["x"],
        "B_k_cache": _B_in["k_cache"],
        "B_v_cache": _B_in["v_cache"],
        "B_wq": _B_in["wq"],
        "B_wo": _B_in["wo"],
    }

def reference(A_x, A_k_cache, A_v_cache, A_wq, A_wo, B_x, B_k_cache, B_v_cache, B_wq, B_wo):
    def _A_ref(x, k_cache, v_cache, wq, wo):
        B, Sq, D = x.shape
        Hq, Dh = 32, 128
        Hkv = k_cache.shape[1]
        rep = Hq // Hkv
        q = (lambda x, *d: x.permute(*d))((x @ wq).reshape(B, Sq, Hq, Dh), 0, 2, 1, 3)
        k = (lambda x, n, axis: torch.repeat_interleave(x, n, dim=axis))(k_cache, rep, axis=1)
        v = (lambda x, n, axis: torch.repeat_interleave(x, n, dim=axis))(v_cache, rep, axis=1)
        scores = torch.einsum("bhqd,bhkd->bhqk", q, k) * (Dh ** -0.5)
        p = _softmax(scores, axis=-1)
        o = torch.einsum("bhqk,bhkd->bhqd", p, v)
        return (lambda x, *d: x.permute(*d))(o, 0, 2, 1, 3).reshape(B, Sq, Hq * Dh) @ wo

    def _B_ref(x, k_cache, v_cache, wq, wo):
        B, Sq, D = x.shape
        Hq, Dh = 32, 128
        Hkv, Sk = k_cache.shape[1], k_cache.shape[2]
        W = min(4096, max(256, Sk // 4))
        rep = Hq // Hkv
        q = (lambda x, *d: x.permute(*d))((x @ wq).reshape(B, Sq, Hq, Dh), 0, 2, 1, 3)
        k = (lambda x, n, axis: torch.repeat_interleave(x, n, dim=axis))(k_cache[:, :, Sk - W:, :], rep, axis=1)
        v = (lambda x, n, axis: torch.repeat_interleave(x, n, dim=axis))(v_cache[:, :, Sk - W:, :], rep, axis=1)
        scores = torch.einsum("bhqd,bhkd->bhqk", q, k) * (Dh ** -0.5)
        p = _softmax(scores, axis=-1)
        o = torch.einsum("bhqk,bhkd->bhqd", p, v)
        return (lambda x, *d: x.permute(*d))(o, 0, 2, 1, 3).reshape(B, Sq, Hq * Dh) @ wo

    a = _A_ref(A_x, A_k_cache, A_v_cache, A_wq, A_wo)
    b = _B_ref(B_x, B_k_cache, B_v_cache, B_wq, B_wo)
    return torch.concatenate([a, b], axis=-1)
```

```asm
; @launch grid=(256,1,1) block=(512,1,1) lds=77824
.amdgcn_target "amdgcn-amd-amdhsa--gfx950"
.text
.globl concat_heads__gqa_block_cached__sliding_block_cached__decode_kernel
.p2align 8
.type concat_heads__gqa_block_cached__sliding_block_cached__decode_kernel,@function
concat_heads__gqa_block_cached__sliding_block_cached__decode_kernel:
    s_cmp_ge_u32 s2, 256
    s_cbranch_scc1 L_end
    s_load_dwordx16 s[4:19], s[0:1], 0
    s_load_dwordx8 s[20:27], s[0:1], 64
    s_load_dwordx2 s[28:29], s[0:1], 96
    v_lshrrev_b32 v1, 6, v0
    v_and_b32 v0, 63, v0
    v_readfirstlane_b32 s3, v1
    s_lshr_b32 s31, s2, 4
    s_and_b32 s30, s2, 15
    s_and_b32 s32, s3, 3
    s_cmp_ge_u32 s3, 4
    s_cbranch_scc1 L_help
    s_setprio 3
    v_mov_b32 v2, 0
    v_mov_b32 v3, 0
    v_mov_b32 v4, 12
    ds_write_b64 v2, v[2:3] offset:0
    ds_write_b64 v2, v[2:3] offset:8
    ds_write_b32 v2, v4 offset:16
    ds_write_b32 v2, v2 offset:24
    s_lshr_b32 s51, s30, 1
    s_add_u32 s51, s51, s31
    s_and_b32 s51, s51, 3
    s_and_b32 s34, s31, 12
    s_add_u32 s34, s34, s32
    s_lshl_b32 s34, s34, 2
    v_lshrrev_b32 v1, 4, v0
    v_add_u32 v1, s34, v1
    v_lshlrev_b32 v2, 4, v1
    v_lshlrev_b32 v3, 1, v1
    v_and_b32 v4, 15, v0
    v_lshlrev_b32 v4, 4, v4
    v_lshl_add_u32 v5, v1, 16, v4
    v_lshl_add_u32 v6, v1, 13, v4
    s_and_b32 s34, s51, 1
    s_lshl_b32 s34, s34, 8
    s_lshl_b32 s35, s30, 9
    s_add_u32 s35, s35, s34
    s_mov_b32 s38, 4718592
    s_mov_b32 s39, 0x20000
    s_mov_b32 s42, 1152
    s_mov_b32 s43, 0x20000
    s_bitcmp1_b32 s51, 1
    s_waitcnt lgkmcnt(0)
    s_cselect_b32 s36, s20, s10
    s_cselect_b32 s37, s21, s11
    s_cselect_b32 s40, s14, s4
    s_cselect_b32 s41, s15, s5
    buffer_load_dwordx4 v[64:67], v5, s[36:39], s35 offen nt
    s_add_u32 s35, s35, 8192
    buffer_load_dwordx4 v[68:71], v5, s[36:39], s35 offen nt
    s_add_u32 s35, s35, 8192
    buffer_load_dwordx4 v[72:75], v5, s[36:39], s35 offen nt
    s_add_u32 s35, s35, 8192
    buffer_load_dwordx4 v[76:79], v5, s[36:39], s35 offen nt
    s_add_u32 s35, s35, 8192
    buffer_load_dwordx4 v[80:83], v5, s[36:39], s35 offen nt
    s_add_u32 s35, s35, 8192
    s_waitcnt vmcnt(4)
    buffer_load_dwordx4 v[84:87], v5, s[36:39], s35 offen nt
    s_add_u32 s35, s35, 8192
    s_waitcnt vmcnt(4)
    buffer_load_dwordx4 v[88:91], v5, s[36:39], s35 offen nt
    s_add_u32 s35, s35, 8192
    s_waitcnt vmcnt(4)
    buffer_load_dwordx4 v[92:95], v5, s[36:39], s35 offen nt
    s_add_u32 s35, s35, 4136960
    s_waitcnt vmcnt(4)
    buffer_load_dwordx4 v[96:99], v6, s[36:39], s35 offen nt
    buffer_load_dwordx4 v[8:11], v2, s[40:43], 0 offen
    buffer_load_ushort v12, v3, s[40:43], 0 offen offset:1024
    s_barrier
    s_load_dword s33, s[28:29], 0
    s_lshl_b32 s48, s30, 8
    s_add_u32 s48, s48, 180224
    v_and_b32 v13, 15, v0
    v_lshl_add_u32 v13, v13, 2, s48
    global_load_dword v13, v13, s[28:29] nt
    v_and_b32 v60, 1, v0
    v_cmp_eq_u32 vcc, 1, v60
    v_mov_b32 v61, 0xffff
    v_mov_b32 v62, 0xffff0000
    v_cndmask_b32 v60, v61, v62, vcc
    v_bfe_u32 v61, v0, 1, 2
    v_cmp_eq_u32 vcc, 0, v61
    s_nop 1
    v_cndmask_b32 v3, 0, v60, vcc
    v_cmp_eq_u32 vcc, 1, v61
    s_nop 1
    v_cndmask_b32 v4, 0, v60, vcc
    v_cmp_eq_u32 vcc, 2, v61
    s_nop 1
    v_cndmask_b32 v5, 0, v60, vcc
    v_cmp_eq_u32 vcc, 3, v61
    s_nop 1
    v_cndmask_b32 v6, 0, v60, vcc
    v_mov_b32 v59, 0xffffff00
    s_mov_b32 s44, 0x01000100
    s_mov_b32 s45, 0x03020302
    s_waitcnt vmcnt(0)
    v_perm_b32 v42, v8, v8, s44
    v_and_b32 v100, v42, v3
    v_and_b32 v101, v42, v4
    v_and_b32 v102, v42, v5
    v_and_b32 v103, v42, v6
    v_perm_b32 v42, v8, v8, s45
    v_and_b32 v104, v42, v3
    v_and_b32 v105, v42, v4
    v_and_b32 v106, v42, v5
    v_and_b32 v107, v42, v6
    v_perm_b32 v42, v9, v9, s44
    v_and_b32 v108, v42, v3
    v_and_b32 v109, v42, v4
    v_and_b32 v110, v42, v5
    v_and_b32 v111, v42, v6
    v_perm_b32 v42, v9, v9, s45
    v_and_b32 v112, v42, v3
    v_and_b32 v113, v42, v4
    v_and_b32 v114, v42, v5
    v_and_b32 v115, v42, v6
    v_perm_b32 v42, v10, v10, s44
    v_and_b32 v116, v42, v3
    v_and_b32 v117, v42, v4
    v_and_b32 v118, v42, v5
    v_and_b32 v119, v42, v6
    v_perm_b32 v42, v10, v10, s45
    v_and_b32 v120, v42, v3
    v_and_b32 v121, v42, v4
    v_and_b32 v122, v42, v5
    v_and_b32 v123, v42, v6
    v_perm_b32 v42, v11, v11, s44
    v_and_b32 v124, v42, v3
    v_and_b32 v125, v42, v4
    v_and_b32 v126, v42, v5
    v_and_b32 v127, v42, v6
    v_perm_b32 v42, v11, v11, s45
    v_and_b32 v128, v42, v3
    v_and_b32 v129, v42, v4
    v_and_b32 v130, v42, v5
    v_and_b32 v131, v42, v6
    v_perm_b32 v42, v12, v12, s44
    v_and_b32 v132, v42, v3
    v_and_b32 v133, v42, v4
    v_and_b32 v134, v42, v5
    v_and_b32 v135, v42, v6
    s_lshl_b32 s35, s32, 9
    v_and_b32 v1, 15, v0
    v_lshlrev_b32 v1, 5, v1
    v_and_b32 v2, 16, v0
    v_add_u32 v1, v1, v2
    v_add_u32 v2, s35, v1
    v_mfma_f32_16x16x32_bf16 v[32:35], v[100:103], v[64:67], 0
    v_mfma_f32_16x16x32_bf16 v[32:35], v[104:107], v[68:71], v[32:35]
    v_mfma_f32_16x16x32_bf16 v[32:35], v[108:111], v[72:75], v[32:35]
    v_mfma_f32_16x16x32_bf16 v[32:35], v[112:115], v[76:79], v[32:35]
    v_mfma_f32_16x16x32_bf16 v[32:35], v[116:119], v[80:83], v[32:35]
    v_mfma_f32_16x16x32_bf16 v[32:35], v[120:123], v[84:87], v[32:35]
    v_mfma_f32_16x16x32_bf16 v[32:35], v[124:127], v[88:91], v[32:35]
    v_mfma_f32_16x16x32_bf16 v[32:35], v[128:131], v[92:95], v[32:35]
    v_mfma_f32_16x16x32_bf16 v[32:35], v[132:135], v[96:99], v[32:35]
    s_lshl_b32 s44, s30, 13
    s_lshl_b32 s35, s51, 11
    s_add_u32 s44, s44, s35
    s_and_b32 s35, s31, 12
    s_lshl_b32 s35, s35, 7
    s_add_u32 s44, s44, s35
    s_add_u32 s44, s44, 4096
    s_lshl_b32 s45, s30, 13
    s_lshl_b32 s35, s32, 11
    s_add_u32 s45, s45, s35
    s_add_u32 s45, s45, 4096
    ds_write_b128 v2, v[32:35] offset:2048
    s_waitcnt lgkmcnt(0)
    s_mul_i32 s33, s33, 0x9e3779b1
    s_add_u32 s33, s33, 0x7f4a7c15
    s_and_b32 s52, s33, 0xff
    s_getreg_b32 s49, hwreg(HW_REG_XCC_ID, 0, 4)
    s_lshl_b32 s49, s49, 28
    s_and_b32 s48, s33, 0xfffffff
    s_or_b32 s48, s48, s49
    v_cmp_ne_u32 vcc, s48, v13
    s_nop 0
    s_cmp_eq_u64 vcc, 0
    s_cselect_b32 s55, 1, 0
    v_mov_b32 v60, 0
    v_mov_b32 v61, 1
    s_mov_b64 exec, 1
    ds_add_rtn_u32 v62, v60, v61 offset:0
    s_mov_b64 exec, -1
    s_waitcnt lgkmcnt(0)
    v_readfirstlane_b32 s35, v62
    s_nop 0
    s_and_b32 s35, s35, 3
    s_cmp_eq_u32 s35, 3
    s_cbranch_scc0 L_q_notlast
    ds_read_b128 v[8:11], v1 offset:2048
    ds_read_b128 v[12:15], v1 offset:2560
    ds_read_b128 v[16:19], v1 offset:3072
    ds_read_b128 v[20:23], v1 offset:3584
    v_add_u32 v2, s44, v1
    s_waitcnt lgkmcnt(0)
    v_add_f32 v8, v8, v12
    v_add_f32 v9, v9, v13
    v_add_f32 v10, v10, v14
    v_add_f32 v11, v11, v15
    v_add_f32 v16, v16, v20
    v_add_f32 v17, v17, v21
    v_add_f32 v18, v18, v22
    v_add_f32 v19, v19, v23
    v_add_f32 v8, v8, v16
    v_add_f32 v9, v9, v17
    v_add_f32 v10, v10, v18
    v_add_f32 v11, v11, v19
    v_add_u32 v8, 0x80, v8
    v_add_u32 v9, 0x80, v9
    v_add_u32 v10, 0x80, v10
    v_add_u32 v11, 0x80, v11
    v_and_or_b32 v8, v8, v59, s52
    v_and_or_b32 v9, v9, v59, s52
    v_and_or_b32 v10, v10, v59, s52
    v_and_or_b32 v11, v11, v59, s52
    s_mov_b32 exec_hi, 0
    s_cmp_eq_u32 s55, 0
    s_cbranch_scc1 L_farq
    global_store_dwordx4 v2, v[8:11], s[28:29]
    s_branch L_sentq
L_farq:
    global_store_dwordx4 v2, v[8:11], s[28:29] sc1
L_sentq:
    s_mov_b64 exec, -1
L_q_notlast:
    v_lshl_add_u32 v19, v0, 4, s45
    s_mov_b32 s47, 0x3e0293ee
    v_bfe_u32 v60, v0, 2, 1
    v_add_u32 v31, -1, v60
    v_bfe_u32 v7, v0, 3, 1
    v_lshlrev_b32 v7, 8, v7
    v_lshrrev_b32 v61, 4, v0
    v_lshl_add_u32 v7, v61, 6, v7
    v_and_b32 v61, 3, v0
    v_lshl_add_u32 v7, v61, 4, v7
    v_mov_b32 v20, 0
    v_mov_b32 v21, 0
    v_mov_b32 v22, 0
    v_mov_b32 v23, 0
    v_mov_b32 v28, 0xff800000
    v_mov_b32 v30, 0
    s_lshl_b32 s48, s30, 14
    s_lshl_b32 s49, s31, 10
    s_add_u32 s48, s48, s49
    s_add_u32 s48, s48, 262144
    v_lshrrev_b32 v57, 5, v0
    v_lshlrev_b32 v58, 2, v57
    v_and_b32 v56, 15, v0
    v_lshlrev_b32 v56, 5, v56
    v_lshl_add_u32 v56, v57, 9, v56
    v_and_b32 v60, 16, v0
    v_add3_u32 v56, v56, v60, s48
    s_mov_b32 s78, 0x84400
    s_mov_b32 s79, 0x202300
    s_mov_b32 s80, 0x696500
    s_mov_b32 s81, 0x119300
    s_mov_b32 s82, 0x20400
    v_lshlrev_b32 v2, 4, v0
    v_and_b32 v100, 3, v0
    v_lshlrev_b32 v100, 4, v100
    v_lshrrev_b32 v60, 4, v0
    v_lshl_add_u32 v100, v60, 6, v100
    v_and_b32 v104, 0xff, v2
    v_bfe_i32 v60, v0, 2, 1
    v_and_b32 v60, 0x2a00, v60
    v_xor_b32 v100, v100, v60
    v_bfe_i32 v60, v0, 3, 1
    v_and_b32 v60, 0x8000, v60
    v_xor_b32 v100, v100, v60
    v_xor_b32 v101, 0x10200, v100
    v_xor_b32 v102, 0x10b00, v100
    v_xor_b32 v103, 0x10b00, v101
    v_bfe_i32 v60, v0, 4, 1
    v_and_b32 v60, 0x2a00, v60
    v_xor_b32 v104, v104, v60
    v_bfe_i32 v60, v0, 5, 1
    v_and_b32 v60, 0x8000, v60
    v_xor_b32 v104, v104, v60
    v_xor_b32 v105, 0x10200, v104
    v_xor_b32 v106, 0x10b00, v104
    v_xor_b32 v107, 0x10b00, v105
    s_mov_b32 s53, 0x0
    s_bitcmp1_b32 s32, 0
    s_cselect_b32 s35, 0x2400, 0
    s_xor_b32 s53, s53, s35
    s_bitcmp1_b32 s32, 1
    s_cselect_b32 s35, 0x41800, 0
    s_xor_b32 s53, s53, s35
    s_bitcmp1_b32 s2, 0
    s_cselect_b32 s35, 0x804a00, 0
    s_xor_b32 s53, s53, s35
    s_bitcmp1_b32 s2, 1
    s_cselect_b32 s35, 0x1121100, 0
    s_xor_b32 s53, s53, s35
    s_bitcmp1_b32 s2, 2
    s_cselect_b32 s35, 0x2068100, 0
    s_xor_b32 s53, s53, s35
    s_bitcmp1_b32 s2, 3
    s_cselect_b32 s35, 0x40c2800, 0
    s_xor_b32 s53, s53, s35
    s_bitcmp1_b32 s2, 4
    s_cselect_b32 s35, 0x44800, 0
    s_xor_b32 s53, s53, s35
    s_bitcmp1_b32 s2, 5
    s_cselect_b32 s35, 0x8100, 0
    s_xor_b32 s53, s53, s35
    s_bitcmp1_b32 s2, 6
    s_cselect_b32 s35, 0x84600, 0
    s_xor_b32 s53, s53, s35
    s_bitcmp1_b32 s2, 7
    s_cselect_b32 s35, 0x40800, 0
    s_xor_b32 s53, s53, s35
    s_mov_b32 s36, s6
    s_mov_b32 s37, s7
    s_mov_b32 s38, 0x8000000
    s_mov_b32 s39, 0x20000
    s_mov_b32 s44, s53
    s_lshl_b32 s35, s32, 14
    s_add_u32 s35, s35, 12288
    v_lshl_add_u32 v16, v0, 4, s35
    v_mov_b32 v17, v16
    s_lshl_b32 s35, s32, 8
    s_add_u32 s35, s35, 1024
    v_and_b32 v18, 31, v0
    v_lshl_add_u32 v18, v18, 3, s35
    v_lshrrev_b32 v60, 5, v0
    v_lshl_add_u32 v18, v60, 2, v18
    s_lshl_b32 s46, s32, 4
    v_add_u32 v58, s46, v58
    s_lshl_b32 s46, s32, 10
    v_lshl_add_u32 v57, v0, 4, s46
    v_mov_b32 v36, 0
    v_mov_b32 v37, 1
    v_mov_b32 v38, 12
    v_mov_b32 v39, -2
    s_mov_b32 s45, 0
    s_mov_b32 s46, 1048576
    s_barrier
L_qpoll:
    s_cmp_eq_u32 s55, 0
    s_cbranch_scc1 L_farp
    global_load_dwordx4 v[8:11], v19, s[28:29] nt
    global_load_dwordx4 v[12:15], v19, s[28:29] offset:1024 nt
    s_branch L_sentp
L_farp:
    global_load_dwordx4 v[8:11], v19, s[28:29] sc1
    global_load_dwordx4 v[12:15], v19, s[28:29] offset:1024 sc1
L_sentp:
    s_cmp_lt_u32 s46, 1048574
    s_cselect_b32 s55, 0, s55
    s_sub_u32 s46, s46, 1
    s_cbranch_scc1 L_qgot
    s_waitcnt vmcnt(0)
    v_xor_b32 v8, s52, v8
    v_xor_b32 v9, s52, v9
    v_xor_b32 v10, s52, v10
    v_xor_b32 v11, s52, v11
    v_xor_b32 v12, s52, v12
    v_xor_b32 v13, s52, v13
    v_xor_b32 v14, s52, v14
    v_xor_b32 v15, s52, v15
    v_or3_b32 v40, v8, v9, v10
    v_or3_b32 v40, v40, v11, v12
    v_or3_b32 v40, v40, v13, v14
    v_bitop3_b32 v40, v40, v59, v15 bitop3:0x32
    v_cmp_ne_u32 vcc, 0, v40
    s_cbranch_vccz L_qgot
    s_sleep 2
    s_branch L_qpoll
L_qgot:
    s_waitcnt vmcnt(0)
    v_add_f32 v8, v8, v12
    v_add_f32 v9, v9, v13
    v_add_f32 v10, v10, v14
    v_add_f32 v11, v11, v15
    s_nop 0
    v_permlane32_swap_b32 v8, v10
    v_permlane32_swap_b32 v9, v11
    v_add_f32 v8, v8, v10
    v_add_f32 v9, v9, v11
    v_cvt_pk_bf16_f32 v8, v8, v9
    ds_write_b32 v18, v8
    s_waitcnt lgkmcnt(0)
    s_barrier
    v_xor_b32 v108, s44, v100
    buffer_load_dwordx4 v[64:67], v108, s[36:39], 0 offen nt
    v_xor_b32 v108, s44, v101
    buffer_load_dwordx4 v[68:71], v108, s[36:39], 0 offen nt
    v_xor_b32 v108, s44, v102
    buffer_load_dwordx4 v[72:75], v108, s[36:39], 0 offen nt
    v_xor_b32 v108, s44, v103
    buffer_load_dwordx4 v[76:79], v108, s[36:39], 0 offen nt
    s_xor_b32 s44, s44, s78
    v_xor_b32 v108, s44, v100
    buffer_load_dwordx4 v[80:83], v108, s[36:39], 0 offen nt
    ds_read_b128 v[12:15], v7 offset:1024
    s_waitcnt lgkmcnt(0)
    v_and_b32 v8, v12, v31
    v_and_b32 v9, v13, v31
    v_and_b32 v10, v14, v31
    v_and_b32 v11, v15, v31
    v_xor_b32 v12, v12, v8
    v_xor_b32 v13, v13, v9
    v_xor_b32 v14, v14, v10
    v_xor_b32 v15, v15, v11
    s_nop 1
    v_xor_b32 v108, s44, v101
    s_waitcnt vmcnt(4)
    buffer_load_dwordx4 v[84:87], v108, s[36:39], 0 offen nt
    v_xor_b32 v108, s44, v102
    s_waitcnt vmcnt(4)
    buffer_load_dwordx4 v[88:91], v108, s[36:39], 0 offen nt
L_kloop:
    s_waitcnt lgkmcnt(0)
    v_readfirstlane_b32 s59, v38
    v_readfirstlane_b32 s57, v39
    s_lshl_b32 s35, s45, 2
    s_sub_i32 s57, s57, s35
    s_cmp_ge_i32 s57, -1
    s_cselect_b32 s35, 5, 0
    s_add_i32 s58, s59, s35
    v_xor_b32 v108, s44, v103
    s_cmp_ge_i32 s58, 1
    s_cbranch_scc1 L_k0a
    s_waitcnt vmcnt(3)
L_k0a:
    s_cmp_ge_i32 s58, 9
    s_cbranch_scc1 L_k0b
    s_waitcnt vmcnt(4)
L_k0b:
    s_cmp_ge_i32 s58, 17
    s_cbranch_scc1 L_k0c
    s_waitcnt vmcnt(5)
L_k0c:
    s_waitcnt vmcnt(6)
    buffer_load_dwordx4 v[92:95], v108, s[36:39], 0 offen nt
    v_mfma_f32_16x16x32_bf16 v[32:35], v[64:67], v[8:11], 0
    s_add_u32 s54, s45, 1
    s_mov_b32 s44, s53
    s_bitcmp1_b32 s54, 0
    s_cselect_b32 s35, s79, 0
    s_xor_b32 s44, s44, s35
    s_bitcmp1_b32 s54, 1
    s_cselect_b32 s35, s80, 0
    s_xor_b32 s44, s44, s35
    s_bitcmp1_b32 s54, 2
    s_cselect_b32 s35, s81, 0
    s_xor_b32 s44, s44, s35
    s_bitcmp1_b32 s54, 3
    s_cselect_b32 s35, s82, 0
    s_xor_b32 s44, s44, s35
    s_cmp_eq_u32 s45, 15
    s_cbranch_scc0 L_kns
    s_mov_b32 s36, s8
    s_mov_b32 s37, s9
    v_mov_b32 v100, v104
    v_mov_b32 v101, v105
    v_mov_b32 v102, v106
    v_mov_b32 v103, v107
L_kns:
    v_xor_b32 v108, s44, v100
    s_cmp_ge_i32 s58, 2
    s_cbranch_scc1 L_k1a
    s_waitcnt vmcnt(3)
L_k1a:
    s_cmp_ge_i32 s58, 10
    s_cbranch_scc1 L_k1b
    s_waitcnt vmcnt(4)
L_k1b:
    s_cmp_ge_i32 s58, 18
    s_cbranch_scc1 L_k1c
    s_waitcnt vmcnt(5)
L_k1c:
    s_waitcnt vmcnt(6)
    buffer_load_dwordx4 v[64:67], v108, s[36:39], 0 offen nt
    v_mfma_f32_16x16x32_bf16 v[32:35], v[68:71], v[12:15], v[32:35]
    s_nop 7
    v_mov_b32_dpp v24, v32 quad_perm:[0,0,0,0] row_mask:0xf bank_mask:0xf
    v_add_f32_dpp v24, v33, v24 quad_perm:[1,1,1,1] row_mask:0xf bank_mask:0xf
    v_add_f32_dpp v24, v34, v24 quad_perm:[2,2,2,2] row_mask:0xf bank_mask:0xf
    v_add_f32_dpp v24, v35, v24 quad_perm:[3,3,3,3] row_mask:0xf bank_mask:0xf
    v_mul_f32 v24, s47, v24
    v_max_f32 v41, v28, v24
    v_sub_f32 v40, v28, v41
    v_sub_f32 v43, v24, v41
    v_exp_f32 v40, v40
    v_exp_f32 v43, v43
    v_mov_b32 v28, v41
    v_fma_f32 v30, v30, v40, v43
    v_xor_b32 v108, s44, v101
    s_cmp_ge_i32 s58, 3
    s_cbranch_scc1 L_k2a
    s_waitcnt vmcnt(3)
L_k2a:
    s_cmp_ge_i32 s58, 11
    s_cbranch_scc1 L_k2b
    s_waitcnt vmcnt(4)
L_k2b:
    s_cmp_ge_i32 s58, 19
    s_cbranch_scc1 L_k2c
    s_waitcnt vmcnt(5)
L_k2c:
    s_waitcnt vmcnt(6)
    buffer_load_dwordx4 v[68:71], v108, s[36:39], 0 offen nt
    v_mfma_f32_16x16x32_bf16 v[32:35], v[72:75], v[8:11], 0
    v_xor_b32 v108, s44, v102
    s_cmp_ge_i32 s58, 4
    s_cbranch_scc1 L_k3a
    s_waitcnt vmcnt(3)
L_k3a:
    s_cmp_ge_i32 s58, 12
    s_cbranch_scc1 L_k3b
    s_waitcnt vmcnt(4)
L_k3b:
    s_cmp_ge_i32 s58, 20
    s_cbranch_scc1 L_k3c
    s_waitcnt vmcnt(5)
L_k3c:
    s_waitcnt vmcnt(6)
    buffer_load_dwordx4 v[72:75], v108, s[36:39], 0 offen nt
    v_mfma_f32_16x16x32_bf16 v[32:35], v[76:79], v[12:15], v[32:35]
    s_nop 7
    v_mov_b32_dpp v25, v32 quad_perm:[0,0,0,0] row_mask:0xf bank_mask:0xf
    v_add_f32_dpp v25, v33, v25 quad_perm:[1,1,1,1] row_mask:0xf bank_mask:0xf
    v_add_f32_dpp v25, v34, v25 quad_perm:[2,2,2,2] row_mask:0xf bank_mask:0xf
    v_add_f32_dpp v25, v35, v25 quad_perm:[3,3,3,3] row_mask:0xf bank_mask:0xf
    v_mul_f32 v25, s47, v25
    v_max_f32 v41, v28, v25
    v_sub_f32 v40, v28, v41
    v_sub_f32 v43, v25, v41
    v_exp_f32 v40, v40
    v_exp_f32 v43, v43
    v_mov_b32 v28, v41
    v_fma_f32 v30, v30, v40, v43
    v_xor_b32 v108, s44, v103
    s_cmp_ge_i32 s58, 5
    s_cbranch_scc1 L_k4a
    s_waitcnt vmcnt(3)
L_k4a:
    s_cmp_ge_i32 s58, 13
    s_cbranch_scc1 L_k4b
    s_waitcnt vmcnt(4)
L_k4b:
    s_cmp_ge_i32 s58, 21
    s_cbranch_scc1 L_k4c
    s_waitcnt vmcnt(5)
L_k4c:
    s_waitcnt vmcnt(6)
    buffer_load_dwordx4 v[76:79], v108, s[36:39], 0 offen nt
    v_mfma_f32_16x16x32_bf16 v[32:35], v[80:83], v[8:11], 0
    s_xor_b32 s44, s44, s78
    v_xor_b32 v108, s44, v100
    s_cmp_ge_i32 s58, 6
    s_cbranch_scc1 L_k5a
    s_waitcnt vmcnt(3)
L_k5a:
    s_cmp_ge_i32 s58, 14
    s_cbranch_scc1 L_k5b
    s_waitcnt vmcnt(4)
L_k5b:
    s_cmp_ge_i32 s58, 22
    s_cbranch_scc1 L_k5c
    s_waitcnt vmcnt(5)
L_k5c:
    s_waitcnt vmcnt(6)
    buffer_load_dwordx4 v[80:83], v108, s[36:39], 0 offen nt
    v_mfma_f32_16x16x32_bf16 v[32:35], v[84:87], v[12:15], v[32:35]
    s_nop 7
    v_mov_b32_dpp v26, v32 quad_perm:[0,0,0,0] row_mask:0xf bank_mask:0xf
    v_add_f32_dpp v26, v33, v26 quad_perm:[1,1,1,1] row_mask:0xf bank_mask:0xf
    v_add_f32_dpp v26, v34, v26 quad_perm:[2,2,2,2] row_mask:0xf bank_mask:0xf
    v_add_f32_dpp v26, v35, v26 quad_perm:[3,3,3,3] row_mask:0xf bank_mask:0xf
    v_mul_f32 v26, s47, v26
    v_max_f32 v41, v28, v26
    v_sub_f32 v40, v28, v41
    v_sub_f32 v43, v26, v41
    v_exp_f32 v40, v40
    v_exp_f32 v43, v43
    v_mov_b32 v28, v41
    v_fma_f32 v30, v30, v40, v43
    v_xor_b32 v108, s44, v101
    s_cmp_ge_i32 s58, 7
    s_cbranch_scc1 L_k6a
    s_waitcnt vmcnt(3)
L_k6a:
    s_cmp_ge_i32 s58, 15
    s_cbranch_scc1 L_k6b
    s_waitcnt vmcnt(4)
L_k6b:
    s_cmp_ge_i32 s58, 23
    s_cbranch_scc1 L_k6c
    s_waitcnt vmcnt(5)
L_k6c:
    s_waitcnt vmcnt(6)
    buffer_load_dwordx4 v[84:87], v108, s[36:39], 0 offen nt
    v_mfma_f32_16x16x32_bf16 v[32:35], v[88:91], v[8:11], 0
    v_xor_b32 v108, s44, v102
    s_cmp_ge_i32 s58, 8
    s_cbranch_scc1 L_k7a
    s_waitcnt vmcnt(3)
L_k7a:
    s_cmp_ge_i32 s58, 16
    s_cbranch_scc1 L_k7b
    s_waitcnt vmcnt(4)
L_k7b:
    s_cmp_ge_i32 s58, 24
    s_cbranch_scc1 L_k7c
    s_waitcnt vmcnt(5)
L_k7c:
    s_waitcnt vmcnt(6)
    buffer_load_dwordx4 v[88:91], v108, s[36:39], 0 offen nt
    ds_read_b32 v38, v36 offset:16
    v_mfma_f32_16x16x32_bf16 v[32:35], v[92:95], v[12:15], v[32:35]
    s_nop 7
    v_mov_b32_dpp v27, v32 quad_perm:[0,0,0,0] row_mask:0xf bank_mask:0xf
    v_add_f32_dpp v27, v33, v27 quad_perm:[1,1,1,1] row_mask:0xf bank_mask:0xf
    v_add_f32_dpp v27, v34, v27 quad_perm:[2,2,2,2] row_mask:0xf bank_mask:0xf
    v_add_f32_dpp v27, v35, v27 quad_perm:[3,3,3,3] row_mask:0xf bank_mask:0xf
    v_mul_f32 v27, s47, v27
    v_max_f32 v41, v28, v27
    v_sub_f32 v40, v28, v41
    v_sub_f32 v43, v27, v41
    v_exp_f32 v40, v40
    v_exp_f32 v43, v43
    v_mov_b32 v28, v41
    v_fma_f32 v30, v30, v40, v43
    ds_write_b128 v16, v[24:27]
    v_add_u32 v16, 1024, v16
    s_mov_b64 exec, 1
    ds_add_rtn_u32 v39, v36, v37 offset:24
    s_mov_b64 exec, -1
    s_add_u32 s45, s45, 1
    s_cmp_lt_u32 s45, 16
    s_cbranch_scc1 L_kloop
    ds_read_b128 v[24:27], v17
    v_mov_b32 v29, v28
    s_nop 1
    v_max_f32_dpp v29, v29, v29 row_half_mirror row_mask:0xf bank_mask:0xf
    v_mov_b32 v60, v29
    s_nop 1
    v_permlane16_swap_b32 v29, v60
    v_max_f32 v29, v29, v60
    v_mov_b32 v60, v29
    s_nop 1
    v_permlane32_swap_b32 v29, v60
    v_max_f32 v29, v29, v60
    v_sub_f32 v40, v28, v29
    v_exp_f32 v40, v40
    s_nop 0
    v_mul_f32 v30, v30, v40
    s_nop 1
    v_add_f32_dpp v30, v30, v30 row_half_mirror row_mask:0xf bank_mask:0xf
    v_mov_b32 v60, v30
    s_nop 1
    v_permlane16_swap_b32 v30, v60
    v_add_f32 v30, v30, v60
    v_mov_b32 v60, v30
    s_nop 1
    v_permlane32_swap_b32 v30, v60
    v_add_f32 v30, v30, v60
    s_lshl_b32 s46, s32, 4
    s_add_u32 s46, s46, 640
    v_and_b32 v61, 8, v0
    v_add_u32 v61, s46, v61
    ds_write2_b32 v61, v29, v30 offset0:0 offset1:1
    s_mov_b64 exec, 1
    ds_add_u32 v36, v37 offset:12
    s_mov_b64 exec, -1
L_vloop:
    s_waitcnt lgkmcnt(0)
    v_readfirstlane_b32 s59, v38
    v_readfirstlane_b32 s57, v39
    s_lshl_b32 s35, s45, 2
    s_sub_i32 s57, s57, s35
    s_cmp_ge_i32 s57, -1
    s_cselect_b32 s35, 5, 0
    s_add_i32 s58, s59, s35
    v_sub_f32 v40, v24, v29
    v_exp_f32 v40, v40
    s_nop 0
    v_cvt_pk_bf16_f32 v42, v40, v40
    v_and_b32 v44, v42, v3
    v_and_b32 v45, v42, v4
    v_and_b32_dpp v46, v42, v5 row_shr:4 row_mask:0xf bank_mask:0xf bound_ctrl:0
    v_and_b32_dpp v47, v42, v6 row_shr:4 row_mask:0xf bank_mask:0xf bound_ctrl:0
    v_xor_b32 v108, s44, v103
    s_cmp_ge_i32 s58, 1
    s_cbranch_scc1 L_v0a
    s_waitcnt vmcnt(3)
L_v0a:
    s_cmp_ge_i32 s58, 9
    s_cbranch_scc1 L_v0b
    s_waitcnt vmcnt(4)
L_v0b:
    s_cmp_ge_i32 s58, 17
    s_cbranch_scc1 L_v0c
    s_waitcnt vmcnt(5)
L_v0c:
    s_waitcnt vmcnt(6)
    buffer_load_dwordx4 v[92:95], v108, s[36:39], 0 offen nt
    v_mfma_f32_16x16x32_bf16 v[20:23], v[44:47], v[64:67], v[20:23]
    v_and_b32_dpp v48, v42, v3 row_shl:4 row_mask:0xf bank_mask:0xf bound_ctrl:0
    v_and_b32_dpp v49, v42, v4 row_shl:4 row_mask:0xf bank_mask:0xf bound_ctrl:0
    v_and_b32 v50, v42, v5
    v_and_b32 v51, v42, v6
    s_add_u32 s54, s45, 1
    s_mov_b32 s44, s53
    s_bitcmp1_b32 s54, 0
    s_cselect_b32 s35, s79, 0
    s_xor_b32 s44, s44, s35
    s_bitcmp1_b32 s54, 1
    s_cselect_b32 s35, s80, 0
    s_xor_b32 s44, s44, s35
    s_bitcmp1_b32 s54, 2
    s_cselect_b32 s35, s81, 0
    s_xor_b32 s44, s44, s35
    s_bitcmp1_b32 s54, 3
    s_cselect_b32 s35, s82, 0
    s_xor_b32 s44, s44, s35
    v_xor_b32 v108, s44, v100
    s_cmp_ge_i32 s58, 2
    s_cbranch_scc1 L_v1a
    s_waitcnt vmcnt(3)
L_v1a:
    s_cmp_ge_i32 s58, 10
    s_cbranch_scc1 L_v1b
    s_waitcnt vmcnt(4)
L_v1b:
    s_cmp_ge_i32 s58, 18
    s_cbranch_scc1 L_v1c
    s_waitcnt vmcnt(5)
L_v1c:
    s_waitcnt vmcnt(6)
    buffer_load_dwordx4 v[64:67], v108, s[36:39], 0 offen nt
    v_mfma_f32_16x16x32_bf16 v[20:23], v[48:51], v[68:71], v[20:23]
    v_sub_f32 v40, v25, v29
    v_exp_f32 v40, v40
    s_nop 0
    v_cvt_pk_bf16_f32 v42, v40, v40
    v_and_b32 v44, v42, v3
    v_and_b32 v45, v42, v4
    v_and_b32_dpp v46, v42, v5 row_shr:4 row_mask:0xf bank_mask:0xf bound_ctrl:0
    v_and_b32_dpp v47, v42, v6 row_shr:4 row_mask:0xf bank_mask:0xf bound_ctrl:0
    v_xor_b32 v108, s44, v101
    s_cmp_ge_i32 s58, 3
    s_cbranch_scc1 L_v2a
    s_waitcnt vmcnt(3)
L_v2a:
    s_cmp_ge_i32 s58, 11
    s_cbranch_scc1 L_v2b
    s_waitcnt vmcnt(4)
L_v2b:
    s_cmp_ge_i32 s58, 19
    s_cbranch_scc1 L_v2c
    s_waitcnt vmcnt(5)
L_v2c:
    s_waitcnt vmcnt(6)
    buffer_load_dwordx4 v[68:71], v108, s[36:39], 0 offen nt
    v_mfma_f32_16x16x32_bf16 v[20:23], v[44:47], v[72:75], v[20:23]
    v_and_b32_dpp v48, v42, v3 row_shl:4 row_mask:0xf bank_mask:0xf bound_ctrl:0
    v_and_b32_dpp v49, v42, v4 row_shl:4 row_mask:0xf bank_mask:0xf bound_ctrl:0
    v_and_b32 v50, v42, v5
    v_and_b32 v51, v42, v6
    v_xor_b32 v108, s44, v102
    s_cmp_ge_i32 s58, 4
    s_cbranch_scc1 L_v3a
    s_waitcnt vmcnt(3)
L_v3a:
    s_cmp_ge_i32 s58, 12
    s_cbranch_scc1 L_v3b
    s_waitcnt vmcnt(4)
L_v3b:
    s_cmp_ge_i32 s58, 20
    s_cbranch_scc1 L_v3c
    s_waitcnt vmcnt(5)
L_v3c:
    s_waitcnt vmcnt(6)
    buffer_load_dwordx4 v[72:75], v108, s[36:39], 0 offen nt
    v_mfma_f32_16x16x32_bf16 v[20:23], v[48:51], v[76:79], v[20:23]
    v_sub_f32 v40, v26, v29
    v_exp_f32 v40, v40
    s_nop 0
    v_cvt_pk_bf16_f32 v42, v40, v40
    v_and_b32 v44, v42, v3
    v_and_b32 v45, v42, v4
    v_and_b32_dpp v46, v42, v5 row_shr:4 row_mask:0xf bank_mask:0xf bound_ctrl:0
    v_and_b32_dpp v47, v42, v6 row_shr:4 row_mask:0xf bank_mask:0xf bound_ctrl:0
    v_xor_b32 v108, s44, v103
    s_cmp_ge_i32 s58, 5
    s_cbranch_scc1 L_v4a
    s_waitcnt vmcnt(3)
L_v4a:
    s_cmp_ge_i32 s58, 13
    s_cbranch_scc1 L_v4b
    s_waitcnt vmcnt(4)
L_v4b:
    s_cmp_ge_i32 s58, 21
    s_cbranch_scc1 L_v4c
    s_waitcnt vmcnt(5)
L_v4c:
    s_waitcnt vmcnt(6)
    buffer_load_dwordx4 v[76:79], v108, s[36:39], 0 offen nt
    v_mfma_f32_16x16x32_bf16 v[20:23], v[44:47], v[80:83], v[20:23]
    v_and_b32_dpp v48, v42, v3 row_shl:4 row_mask:0xf bank_mask:0xf bound_ctrl:0
    v_and_b32_dpp v49, v42, v4 row_shl:4 row_mask:0xf bank_mask:0xf bound_ctrl:0
    v_and_b32 v50, v42, v5
    v_and_b32 v51, v42, v6
    s_xor_b32 s44, s44, s78
    v_xor_b32 v108, s44, v100
    s_cmp_ge_i32 s58, 6
    s_cbranch_scc1 L_v5a
    s_waitcnt vmcnt(3)
L_v5a:
    s_cmp_ge_i32 s58, 14
    s_cbranch_scc1 L_v5b
    s_waitcnt vmcnt(4)
L_v5b:
    s_cmp_ge_i32 s58, 22
    s_cbranch_scc1 L_v5c
    s_waitcnt vmcnt(5)
L_v5c:
    s_waitcnt vmcnt(6)
    buffer_load_dwordx4 v[80:83], v108, s[36:39], 0 offen nt
    v_mfma_f32_16x16x32_bf16 v[20:23], v[48:51], v[84:87], v[20:23]
    v_sub_f32 v40, v27, v29
    v_exp_f32 v40, v40
    s_nop 0
    v_cvt_pk_bf16_f32 v42, v40, v40
    v_add_u32 v17, 1024, v17
    ds_read_b128 v[24:27], v17
    v_and_b32 v44, v42, v3
    v_and_b32 v45, v42, v4
    v_and_b32_dpp v46, v42, v5 row_shr:4 row_mask:0xf bank_mask:0xf bound_ctrl:0
    v_and_b32_dpp v47, v42, v6 row_shr:4 row_mask:0xf bank_mask:0xf bound_ctrl:0
    v_xor_b32 v108, s44, v101
    s_cmp_ge_i32 s58, 7
    s_cbranch_scc1 L_v6a
    s_waitcnt vmcnt(3)
L_v6a:
    s_cmp_ge_i32 s58, 15
    s_cbranch_scc1 L_v6b
    s_waitcnt vmcnt(4)
L_v6b:
    s_cmp_ge_i32 s58, 23
    s_cbranch_scc1 L_v6c
    s_waitcnt vmcnt(5)
L_v6c:
    s_waitcnt vmcnt(6)
    buffer_load_dwordx4 v[84:87], v108, s[36:39], 0 offen nt
    v_mfma_f32_16x16x32_bf16 v[20:23], v[44:47], v[88:91], v[20:23]
    v_and_b32_dpp v48, v42, v3 row_shl:4 row_mask:0xf bank_mask:0xf bound_ctrl:0
    v_and_b32_dpp v49, v42, v4 row_shl:4 row_mask:0xf bank_mask:0xf bound_ctrl:0
    v_and_b32 v50, v42, v5
    v_and_b32 v51, v42, v6
    v_xor_b32 v108, s44, v102
    s_cmp_ge_i32 s58, 8
    s_cbranch_scc1 L_v7a
    s_waitcnt vmcnt(3)
L_v7a:
    s_cmp_ge_i32 s58, 16
    s_cbranch_scc1 L_v7b
    s_waitcnt vmcnt(4)
L_v7b:
    s_cmp_ge_i32 s58, 24
    s_cbranch_scc1 L_v7c
    s_waitcnt vmcnt(5)
L_v7c:
    s_waitcnt vmcnt(6)
    buffer_load_dwordx4 v[88:91], v108, s[36:39], 0 offen nt
    ds_read_b32 v38, v36 offset:16
    v_mfma_f32_16x16x32_bf16 v[20:23], v[48:51], v[92:95], v[20:23]
    s_mov_b64 exec, 1
    ds_add_rtn_u32 v39, v36, v37 offset:24
    s_mov_b64 exec, -1
    s_add_u32 s45, s45, 1
    s_cmp_lt_u32 s45, 31
    s_cbranch_scc1 L_vloop
    s_waitcnt lgkmcnt(0)
    v_sub_f32 v40, v24, v29
    v_exp_f32 v40, v40
    s_nop 0
    v_cvt_pk_bf16_f32 v42, v40, v40
    v_and_b32 v44, v42, v3
    v_and_b32 v45, v42, v4
    v_and_b32_dpp v46, v42, v5 row_shr:4 row_mask:0xf bank_mask:0xf bound_ctrl:0
    v_and_b32_dpp v47, v42, v6 row_shr:4 row_mask:0xf bank_mask:0xf bound_ctrl:0
    v_xor_b32 v108, s44, v103
    s_waitcnt vmcnt(6)
    buffer_load_dwordx4 v[92:95], v108, s[36:39], 0 offen nt
    v_mfma_f32_16x16x32_bf16 v[20:23], v[44:47], v[64:67], v[20:23]
    v_and_b32_dpp v48, v42, v3 row_shl:4 row_mask:0xf bank_mask:0xf bound_ctrl:0
    v_and_b32_dpp v49, v42, v4 row_shl:4 row_mask:0xf bank_mask:0xf bound_ctrl:0
    v_and_b32 v50, v42, v5
    v_and_b32 v51, v42, v6
    s_barrier
    ds_read_b32 v30, v58 offset:768
    ds_read_b32 v38, v36 offset:20
    s_waitcnt vmcnt(6)
    s_nop 0
    v_mfma_f32_16x16x32_bf16 v[20:23], v[48:51], v[68:71], v[20:23]
    v_sub_f32 v40, v25, v29
    v_exp_f32 v40, v40
    s_nop 0
    v_cvt_pk_bf16_f32 v42, v40, v40
    v_and_b32 v44, v42, v3
    v_and_b32 v45, v42, v4
    v_and_b32_dpp v46, v42, v5 row_shr:4 row_mask:0xf bank_mask:0xf bound_ctrl:0
    v_and_b32_dpp v47, v42, v6 row_shr:4 row_mask:0xf bank_mask:0xf bound_ctrl:0
    s_waitcnt vmcnt(5)
    s_nop 0
    v_mfma_f32_16x16x32_bf16 v[20:23], v[44:47], v[72:75], v[20:23]
    v_and_b32_dpp v48, v42, v3 row_shl:4 row_mask:0xf bank_mask:0xf bound_ctrl:0
    v_and_b32_dpp v49, v42, v4 row_shl:4 row_mask:0xf bank_mask:0xf bound_ctrl:0
    v_and_b32 v50, v42, v5
    v_and_b32 v51, v42, v6
    s_waitcnt vmcnt(4)
    s_nop 0
    v_mfma_f32_16x16x32_bf16 v[20:23], v[48:51], v[76:79], v[20:23]
    v_sub_f32 v40, v26, v29
    v_exp_f32 v40, v40
    s_nop 0
    v_cvt_pk_bf16_f32 v42, v40, v40
    v_and_b32 v44, v42, v3
    v_and_b32 v45, v42, v4
    v_and_b32_dpp v46, v42, v5 row_shr:4 row_mask:0xf bank_mask:0xf bound_ctrl:0
    v_and_b32_dpp v47, v42, v6 row_shr:4 row_mask:0xf bank_mask:0xf bound_ctrl:0
    s_waitcnt vmcnt(3)
    s_nop 0
    v_mfma_f32_16x16x32_bf16 v[20:23], v[44:47], v[80:83], v[20:23]
    v_and_b32_dpp v48, v42, v3 row_shl:4 row_mask:0xf bank_mask:0xf bound_ctrl:0
    v_and_b32_dpp v49, v42, v4 row_shl:4 row_mask:0xf bank_mask:0xf bound_ctrl:0
    v_and_b32 v50, v42, v5
    v_and_b32 v51, v42, v6
    s_waitcnt vmcnt(2)
    s_nop 0
    v_mfma_f32_16x16x32_bf16 v[20:23], v[48:51], v[84:87], v[20:23]
    v_sub_f32 v40, v27, v29
    v_exp_f32 v40, v40
    s_nop 0
    v_cvt_pk_bf16_f32 v42, v40, v40
    v_and_b32 v44, v42, v3
    v_and_b32 v45, v42, v4
    v_and_b32_dpp v46, v42, v5 row_shr:4 row_mask:0xf bank_mask:0xf bound_ctrl:0
    v_and_b32_dpp v47, v42, v6 row_shr:4 row_mask:0xf bank_mask:0xf bound_ctrl:0
    s_waitcnt vmcnt(1)
    s_nop 0
    v_mfma_f32_16x16x32_bf16 v[20:23], v[44:47], v[88:91], v[20:23]
    v_and_b32_dpp v48, v42, v3 row_shl:4 row_mask:0xf bank_mask:0xf bound_ctrl:0
    v_and_b32_dpp v49, v42, v4 row_shl:4 row_mask:0xf bank_mask:0xf bound_ctrl:0
    v_and_b32 v50, v42, v5
    v_and_b32 v51, v42, v6
    s_waitcnt lgkmcnt(0)
    v_readfirstlane_b32 s55, v38
    s_waitcnt vmcnt(0)
    s_nop 0
    v_mfma_f32_16x16x32_bf16 v[20:23], v[48:51], v[92:95], v[20:23]
    v_mov_b32 v60, 0
    v_mov_b32 v61, 1
    s_nop 5
    v_pk_mul_f32 v[32:33], v[20:21], v[30:31] op_sel_hi:[1,0]
    v_pk_mul_f32 v[34:35], v[22:23], v[30:31] op_sel_hi:[1,0]
    ds_write_b128 v57, v[32:35] offset:4096
    s_mov_b64 exec, 1
    ds_add_rtn_u32 v62, v60, v61 offset:4
    s_mov_b64 exec, -1
    ds_read_b128 v[12:15], v2 offset:4096
    ds_read_b128 v[16:19], v2 offset:5120
    ds_read_b128 v[20:23], v2 offset:6144
    ds_read_b128 v[24:27], v2 offset:7168
    s_waitcnt lgkmcnt(4)
    v_readfirstlane_b32 s35, v62
    s_nop 0
    s_and_b32 s35, s35, 3
    s_cmp_eq_u32 s35, 3
    s_cbranch_scc0 L_senta
    s_waitcnt lgkmcnt(2)
    v_pk_add_f32 v[12:13], v[12:13], v[16:17]
    v_pk_add_f32 v[14:15], v[14:15], v[18:19]
    s_waitcnt lgkmcnt(0)
    v_pk_add_f32 v[20:21], v[20:21], v[24:25]
    v_pk_add_f32 v[22:23], v[22:23], v[26:27]
    v_pk_add_f32 v[44:45], v[12:13], v[20:21]
    v_pk_add_f32 v[46:47], v[14:15], v[22:23]
    v_and_or_b32 v44, v44, v59, s52
    v_and_or_b32 v45, v45, v59, s52
    v_and_or_b32 v46, v46, v59, s52
    v_and_or_b32 v47, v47, v59, s52
    s_cmp_eq_u32 s55, 0
    s_cbranch_scc1 L_fara
    global_store_dwordx4 v56, v[44:47], s[28:29]
    s_branch L_senta
L_fara:
    global_store_dwordx4 v56, v[44:47], s[28:29] sc1
L_senta:
    s_barrier
L_end:
    s_endpgm
L_help:
    s_mov_b32 s78, 0x80400
    s_mov_b32 s79, 0xf4a00
    v_lshlrev_b32 v2, 4, v0
    v_and_b32 v240, 3, v0
    v_lshlrev_b32 v240, 4, v240
    v_lshrrev_b32 v60, 4, v0
    v_lshl_add_u32 v240, v60, 6, v240
    v_and_b32 v244, 0xff, v2
    v_bfe_i32 v60, v0, 2, 1
    v_and_b32 v60, 0x100, v60
    v_xor_b32 v240, v240, v60
    v_bfe_i32 v60, v0, 3, 1
    v_and_b32 v60, 0x2a00, v60
    v_xor_b32 v240, v240, v60
    v_xor_b32 v241, 0x4000, v240
    v_xor_b32 v242, 0x8900, v240
    v_xor_b32 v243, 0x8900, v241
    v_bfe_i32 v60, v0, 4, 1
    v_and_b32 v60, 0x100, v60
    v_xor_b32 v244, v244, v60
    v_bfe_i32 v60, v0, 5, 1
    v_and_b32 v60, 0x2a00, v60
    v_xor_b32 v244, v244, v60
    v_xor_b32 v245, 0x4000, v244
    v_xor_b32 v246, 0x8900, v244
    v_xor_b32 v247, 0x8900, v245
    s_mov_b32 s53, 0x700000
    s_bitcmp1_b32 s32, 0
    s_cselect_b32 s35, 0x15300, 0
    s_xor_b32 s53, s53, s35
    s_bitcmp1_b32 s32, 1
    s_cselect_b32 s35, 0x1a700, 0
    s_xor_b32 s53, s53, s35
    s_bitcmp1_b32 s2, 0
    s_cselect_b32 s35, 0x89d300, 0
    s_xor_b32 s53, s53, s35
    s_bitcmp1_b32 s2, 1
    s_cselect_b32 s35, 0x10d4a00, 0
    s_xor_b32 s53, s53, s35
    s_bitcmp1_b32 s2, 2
    s_cselect_b32 s35, 0x2020900, 0
    s_xor_b32 s53, s53, s35
    s_bitcmp1_b32 s2, 3
    s_cselect_b32 s35, 0x402e100, 0
    s_xor_b32 s53, s53, s35
    s_bitcmp1_b32 s2, 4
    s_cselect_b32 s35, 0x8100, 0
    s_xor_b32 s53, s53, s35
    s_bitcmp1_b32 s2, 5
    s_cselect_b32 s35, 0x1000, 0
    s_xor_b32 s53, s53, s35
    s_bitcmp1_b32 s2, 6
    s_cselect_b32 s35, 0x19100, 0
    s_xor_b32 s53, s53, s35
    s_bitcmp1_b32 s2, 7
    s_cselect_b32 s35, 0x45d00, 0
    s_xor_b32 s53, s53, s35
    s_mov_b32 s44, s53
    s_mov_b32 s38, 0x8000000
    s_mov_b32 s39, 0x20000
    s_mov_b32 s42, 0x8000000
    s_mov_b32 s43, 0x20000
    s_waitcnt lgkmcnt(0)
    s_mov_b32 s36, s16
    s_mov_b32 s37, s17
    s_mov_b32 s40, s18
    s_mov_b32 s41, s19
    s_load_dword s33, s[28:29], 0
    v_bfe_u32 v62, v0, 3, 1
    v_lshrrev_b32 v60, 4, v0
    v_lshl_add_u32 v62, v62, 5, v60
    v_and_b32 v61, 7, v0
    v_mul_u32_u24 v249, 1152, v62
    v_lshl_add_u32 v249, v61, 4, v249
    v_and_b32 v250, 15, v0
    v_lshlrev_b32 v250, 4, v250
    v_lshl_add_u32 v250, v60, 12, v250
    v_lshrrev_b32 v60, 5, v0
    v_lshlrev_b32 v251, 8, v60
    v_lshl_add_u32 v251, v61, 5, v251
    v_and_b32 v60, 16, v0
    s_lshl_b32 s46, s32, 9
    v_add3_u32 v251, v251, v60, s46
    v_lshlrev_b32 v252, 2, v0
    s_mov_b32 s86, 4718592
    s_mov_b32 s87, 0x20000
    s_cmp_le_u32 s31, 8
    s_cselect_b32 s50, 0, 1
    s_cselect_b32 s84, s12, s22
    s_cselect_b32 s85, s13, s23
    s_cselect_b32 s51, 0, 9
    s_sub_u32 s51, s31, s51
    s_lshl_b32 s34, s30, 2
    s_add_u32 s34, s34, s32
    s_mul_i32 s34, s34, 73728
    s_lshl_b32 s45, s51, 7
    s_add_u32 s34, s34, s45
    s_lshl_b32 s46, s50, 4
    s_add_u32 s46, s46, s30
    s_lshl_b32 s46, s46, 14
    s_lshl_b32 s48, s32, 8
    s_add_u32 s46, s46, s48
    s_add_u32 s46, s46, 262144
    v_add_u32 v253, s46, v250
    s_mul_i32 s46, s50, 9
    s_add_u32 s46, s46, s51
    s_lshl_b32 s46, s46, 4
    s_add_u32 s46, s46, s30
    s_lshl_b32 s46, s46, 8
    s_add_u32 s46, s46, 786432
    v_add_u32 v254, s46, v252
    s_and_b32 s46, s51, 3
    s_cmp_eq_u32 s46, s32
    s_cselect_b32 s56, s50, 0
    s_lshl_b32 s46, s31, 2
    s_add_u32 s46, s46, s32
    s_cmp_eq_u32 s46, 39
    s_cselect_b32 s56, 1, s56
    s_cselect_b32 s46, 7, s51
    s_lshr_b32 s46, s46, 2
    s_sub_u32 s48, s46, s51
    s_add_u32 s48, s48, 7
    s_lshl_b32 s48, s48, 7
    s_add_u32 s55, s34, s48
    s_lshl_b32 s46, s46, 4
    s_add_u32 s46, s46, s30
    s_lshl_b32 s46, s46, 2
    s_add_u32 s46, s46, s32
    s_lshl_b32 s46, s46, 8
    s_add_u32 s46, s46, 868352
    v_lshlrev_b32 v255, 5, v61
    v_add3_u32 v255, v255, v60, s46
    s_mov_b32 s3, s55
    s_waitcnt lgkmcnt(0)
    s_mul_i32 s33, s33, 0x9e3779b1
    s_add_u32 s33, s33, 0x7f4a7c15
    s_and_b32 s52, s33, 0xff
    s_cmp_eq_u32 s32, 0
    s_cbranch_scc0 L_noid
    s_getreg_b32 s49, hwreg(HW_REG_XCC_ID, 0, 4)
    s_lshl_b32 s49, s49, 28
    s_and_b32 s46, s33, 0xfffffff
    s_or_b32 s46, s46, s49
    s_lshl_b32 s48, s30, 8
    s_lshl_b32 s49, s31, 2
    s_add_u32 s48, s48, s49
    s_add_u32 s48, s48, 180224
    v_mov_b32 v60, s48
    v_mov_b32 v61, s46
    s_mov_b64 exec, 1
    global_store_dword v60, v61, s[28:29]
    s_mov_b64 exec, -1
L_noid:
    s_barrier
    v_xor_b32 v248, s44, v240
    buffer_load_dwordx4 v[64:67], v248, s[36:39], 0 offen nt
    v_xor_b32 v248, s44, v241
    buffer_load_dwordx4 v[68:71], v248, s[36:39], 0 offen nt
    v_xor_b32 v248, s44, v242
    buffer_load_dwordx4 v[72:75], v248, s[36:39], 0 offen nt
    v_xor_b32 v248, s44, v243
    buffer_load_dwordx4 v[76:79], v248, s[36:39], 0 offen nt
    s_xor_b32 s44, s44, s78
    v_xor_b32 v248, s44, v240
    buffer_load_dwordx4 v[80:83], v248, s[36:39], 0 offen nt
    v_xor_b32 v248, s44, v241
    buffer_load_dwordx4 v[84:87], v248, s[36:39], 0 offen nt
    v_xor_b32 v248, s44, v242
    s_waitcnt vmcnt(5)
    buffer_load_dwordx4 v[88:91], v248, s[36:39], 0 offen nt
    v_xor_b32 v248, s44, v243
    s_waitcnt vmcnt(5)
    buffer_load_dwordx4 v[92:95], v248, s[36:39], 0 offen nt
    s_xor_b32 s44, s44, s78
    s_xor_b32 s44, s44, s79
    v_xor_b32 v248, s44, v240
    s_waitcnt vmcnt(5)
    buffer_load_dwordx4 v[96:99], v248, s[36:39], 0 offen nt
    v_xor_b32 v248, s44, v241
    s_waitcnt vmcnt(5)
    buffer_load_dwordx4 v[100:103], v248, s[36:39], 0 offen nt
    v_xor_b32 v248, s44, v242
    s_waitcnt vmcnt(5)
    buffer_load_dwordx4 v[104:107], v248, s[36:39], 0 offen nt
    v_xor_b32 v248, s44, v243
    s_waitcnt vmcnt(5)
    buffer_load_dwordx4 v[108:111], v248, s[36:39], 0 offen nt
    s_xor_b32 s44, s44, s78
    v_xor_b32 v248, s44, v240
    s_waitcnt vmcnt(5)
    buffer_load_dwordx4 v[112:115], v248, s[36:39], 0 offen nt
    v_xor_b32 v248, s44, v241
    s_waitcnt vmcnt(5)
    buffer_load_dwordx4 v[116:119], v248, s[36:39], 0 offen nt
    v_xor_b32 v248, s44, v242
    s_waitcnt vmcnt(5)
    buffer_load_dwordx4 v[120:123], v248, s[36:39], 0 offen nt
    v_xor_b32 v248, s44, v243
    s_waitcnt vmcnt(5)
    buffer_load_dwordx4 v[124:127], v248, s[36:39], 0 offen nt
    s_xor_b32 s44, s44, s78
    s_xor_b32 s44, s44, s79
    v_xor_b32 v248, s44, v244
    s_waitcnt vmcnt(5)
    buffer_load_dwordx4 v[128:131], v248, s[40:43], 0 offen nt
    v_xor_b32 v248, s44, v245
    s_waitcnt vmcnt(5)
    buffer_load_dwordx4 v[132:135], v248, s[40:43], 0 offen nt
    v_xor_b32 v248, s44, v246
    s_waitcnt vmcnt(5)
    buffer_load_dwordx4 v[136:139], v248, s[40:43], 0 offen nt
    v_xor_b32 v248, s44, v247
    s_waitcnt vmcnt(5)
    buffer_load_dwordx4 v[140:143], v248, s[40:43], 0 offen nt
    s_xor_b32 s44, s44, s78
    v_xor_b32 v248, s44, v244
    s_waitcnt vmcnt(5)
    buffer_load_dwordx4 v[144:147], v248, s[40:43], 0 offen nt
    v_xor_b32 v248, s44, v245
    s_waitcnt vmcnt(5)
    buffer_load_dwordx4 v[148:151], v248, s[40:43], 0 offen nt
    v_xor_b32 v248, s44, v246
    s_waitcnt vmcnt(5)
    buffer_load_dwordx4 v[152:155], v248, s[40:43], 0 offen nt
    v_xor_b32 v248, s44, v247
    s_waitcnt vmcnt(5)
    buffer_load_dwordx4 v[156:159], v248, s[40:43], 0 offen nt
    s_xor_b32 s44, s44, s78
    s_xor_b32 s44, s44, s79
    v_xor_b32 v248, s44, v244
    s_waitcnt vmcnt(5)
    s_barrier
    buffer_load_dwordx4 v[160:163], v248, s[40:43], 0 offen nt
    v_xor_b32 v248, s44, v245
    s_waitcnt vmcnt(5)
    buffer_load_dwordx4 v[164:167], v248, s[40:43], 0 offen nt
    v_xor_b32 v248, s44, v246
    s_waitcnt vmcnt(5)
    buffer_load_dwordx4 v[168:171], v248, s[40:43], 0 offen nt
    v_xor_b32 v248, s44, v247
    s_waitcnt vmcnt(5)
    buffer_load_dwordx4 v[172:175], v248, s[40:43], 0 offen nt
    s_xor_b32 s44, s44, s78
    v_xor_b32 v248, s44, v244
    s_waitcnt vmcnt(5)
    buffer_load_dwordx4 v[176:179], v248, s[40:43], 0 offen nt
    v_xor_b32 v248, s44, v245
    s_waitcnt vmcnt(5)
    buffer_load_dwordx4 v[180:183], v248, s[40:43], 0 offen nt
    v_xor_b32 v248, s44, v246
    s_waitcnt vmcnt(5)
    buffer_load_dwordx4 v[184:187], v248, s[40:43], 0 offen nt
    v_xor_b32 v248, s44, v247
    s_waitcnt vmcnt(5)
    buffer_load_dwordx4 v[188:191], v248, s[40:43], 0 offen nt
    s_barrier
    v_and_b32 v60, 1, v0
    v_cmp_eq_u32 vcc, 1, v60
    v_mov_b32 v61, 0xffff
    v_mov_b32 v62, 0xffff0000
    v_cndmask_b32 v60, v61, v62, vcc
    v_bfe_u32 v61, v0, 1, 2
    v_cmp_eq_u32 vcc, 0, v61
    s_nop 1
    v_cndmask_b32 v3, 0, v60, vcc
    v_cmp_eq_u32 vcc, 1, v61
    s_nop 1
    v_cndmask_b32 v4, 0, v60, vcc
    v_cmp_eq_u32 vcc, 2, v61
    s_nop 1
    v_cndmask_b32 v5, 0, v60, vcc
    v_cmp_eq_u32 vcc, 3, v61
    s_nop 1
    v_cndmask_b32 v6, 0, v60, vcc
    v_mov_b32 v59, 0xffffff00
    s_mov_b32 s47, 0x3e0293ee
    v_bfe_u32 v60, v0, 2, 1
    v_add_u32 v31, -1, v60
    v_bfe_u32 v7, v0, 3, 1
    v_lshlrev_b32 v7, 8, v7
    v_lshrrev_b32 v61, 4, v0
    v_lshl_add_u32 v7, v61, 6, v7
    v_and_b32 v61, 3, v0
    v_lshl_add_u32 v7, v61, 4, v7
    v_mov_b32 v20, 0
    v_mov_b32 v21, 0
    v_mov_b32 v22, 0
    v_mov_b32 v23, 0
    v_mov_b32 v28, 0xff800000
    v_mov_b32 v30, 0
    ds_read_b128 v[12:15], v7 offset:1536
    s_waitcnt lgkmcnt(0)
    v_and_b32 v8, v12, v31
    v_and_b32 v9, v13, v31
    v_and_b32 v10, v14, v31
    v_and_b32 v11, v15, v31
    v_xor_b32 v12, v12, v8
    v_xor_b32 v13, v13, v9
    v_xor_b32 v14, v14, v10
    v_xor_b32 v15, v15, v11
    s_nop 1
    v_mfma_f32_16x16x32_bf16 v[32:35], v[64:67], v[8:11], 0
    v_mfma_f32_16x16x32_bf16 v[32:35], v[68:71], v[12:15], v[32:35]
    s_nop 4
    s_nop 1
    v_mfma_f32_16x16x32_bf16 v[36:39], v[72:75], v[8:11], 0
    v_mfma_f32_16x16x32_bf16 v[36:39], v[76:79], v[12:15], v[36:39]
    v_mov_b32_dpp v48, v32 quad_perm:[0,0,0,0] row_mask:0xf bank_mask:0xf
    v_add_f32_dpp v48, v33, v48 quad_perm:[1,1,1,1] row_mask:0xf bank_mask:0xf
    v_add_f32_dpp v48, v34, v48 quad_perm:[2,2,2,2] row_mask:0xf bank_mask:0xf
    v_add_f32_dpp v48, v35, v48 quad_perm:[3,3,3,3] row_mask:0xf bank_mask:0xf
    v_mul_f32 v48, s47, v48
    v_max_f32 v28, v28, v48
    s_nop 1
    v_mfma_f32_16x16x32_bf16 v[32:35], v[80:83], v[8:11], 0
    v_mfma_f32_16x16x32_bf16 v[32:35], v[84:87], v[12:15], v[32:35]
    v_mov_b32_dpp v49, v36 quad_perm:[0,0,0,0] row_mask:0xf bank_mask:0xf
    v_add_f32_dpp v49, v37, v49 quad_perm:[1,1,1,1] row_mask:0xf bank_mask:0xf
    v_add_f32_dpp v49, v38, v49 quad_perm:[2,2,2,2] row_mask:0xf bank_mask:0xf
    v_add_f32_dpp v49, v39, v49 quad_perm:[3,3,3,3] row_mask:0xf bank_mask:0xf
    v_mul_f32 v49, s47, v49
    v_max_f32 v28, v28, v49
    s_nop 1
    v_mfma_f32_16x16x32_bf16 v[36:39], v[88:91], v[8:11], 0
    v_mfma_f32_16x16x32_bf16 v[36:39], v[92:95], v[12:15], v[36:39]
    v_mov_b32_dpp v50, v32 quad_perm:[0,0,0,0] row_mask:0xf bank_mask:0xf
    v_add_f32_dpp v50, v33, v50 quad_perm:[1,1,1,1] row_mask:0xf bank_mask:0xf
    v_add_f32_dpp v50, v34, v50 quad_perm:[2,2,2,2] row_mask:0xf bank_mask:0xf
    v_add_f32_dpp v50, v35, v50 quad_perm:[3,3,3,3] row_mask:0xf bank_mask:0xf
    v_mul_f32 v50, s47, v50
    v_max_f32 v28, v28, v50
    s_nop 1
    v_mfma_f32_16x16x32_bf16 v[32:35], v[96:99], v[8:11], 0
    v_mfma_f32_16x16x32_bf16 v[32:35], v[100:103], v[12:15], v[32:35]
    v_mov_b32_dpp v51, v36 quad_perm:[0,0,0,0] row_mask:0xf bank_mask:0xf
    v_add_f32_dpp v51, v37, v51 quad_perm:[1,1,1,1] row_mask:0xf bank_mask:0xf
    v_add_f32_dpp v51, v38, v51 quad_perm:[2,2,2,2] row_mask:0xf bank_mask:0xf
    v_add_f32_dpp v51, v39, v51 quad_perm:[3,3,3,3] row_mask:0xf bank_mask:0xf
    v_mul_f32 v51, s47, v51
    v_max_f32 v28, v28, v51
    s_nop 1
    v_mfma_f32_16x16x32_bf16 v[36:39], v[104:107], v[8:11], 0
    v_mfma_f32_16x16x32_bf16 v[36:39], v[108:111], v[12:15], v[36:39]
    v_mov_b32_dpp v52, v32 quad_perm:[0,0,0,0] row_mask:0xf bank_mask:0xf
    v_add_f32_dpp v52, v33, v52 quad_perm:[1,1,1,1] row_mask:0xf bank_mask:0xf
    v_add_f32_dpp v52, v34, v52 quad_perm:[2,2,2,2] row_mask:0xf bank_mask:0xf
    v_add_f32_dpp v52, v35, v52 quad_perm:[3,3,3,3] row_mask:0xf bank_mask:0xf
    v_mul_f32 v52, s47, v52
    v_max_f32 v28, v28, v52
    s_nop 1
    v_mfma_f32_16x16x32_bf16 v[32:35], v[112:115], v[8:11], 0
    v_mfma_f32_16x16x32_bf16 v[32:35], v[116:119], v[12:15], v[32:35]
    v_mov_b32_dpp v53, v36 quad_perm:[0,0,0,0] row_mask:0xf bank_mask:0xf
    v_add_f32_dpp v53, v37, v53 quad_perm:[1,1,1,1] row_mask:0xf bank_mask:0xf
    v_add_f32_dpp v53, v38, v53 quad_perm:[2,2,2,2] row_mask:0xf bank_mask:0xf
    v_add_f32_dpp v53, v39, v53 quad_perm:[3,3,3,3] row_mask:0xf bank_mask:0xf
    v_mul_f32 v53, s47, v53
    v_max_f32 v28, v28, v53
    s_nop 1
    v_mfma_f32_16x16x32_bf16 v[36:39], v[120:123], v[8:11], 0
    v_mfma_f32_16x16x32_bf16 v[36:39], v[124:127], v[12:15], v[36:39]
    v_mov_b32_dpp v54, v32 quad_perm:[0,0,0,0] row_mask:0xf bank_mask:0xf
    v_add_f32_dpp v54, v33, v54 quad_perm:[1,1,1,1] row_mask:0xf bank_mask:0xf
    v_add_f32_dpp v54, v34, v54 quad_perm:[2,2,2,2] row_mask:0xf bank_mask:0xf
    v_add_f32_dpp v54, v35, v54 quad_perm:[3,3,3,3] row_mask:0xf bank_mask:0xf
    v_mul_f32 v54, s47, v54
    v_max_f32 v28, v28, v54
    s_nop 1
    s_nop 1
    v_mov_b32_dpp v55, v36 quad_perm:[0,0,0,0] row_mask:0xf bank_mask:0xf
    v_add_f32_dpp v55, v37, v55 quad_perm:[1,1,1,1] row_mask:0xf bank_mask:0xf
    v_add_f32_dpp v55, v38, v55 quad_perm:[2,2,2,2] row_mask:0xf bank_mask:0xf
    v_add_f32_dpp v55, v39, v55 quad_perm:[3,3,3,3] row_mask:0xf bank_mask:0xf
    v_mul_f32 v55, s47, v55
    v_max_f32 v28, v28, v55
    s_nop 1
    v_max_f32_dpp v28, v28, v28 row_half_mirror row_mask:0xf bank_mask:0xf
    v_mov_b32 v60, v28
    s_nop 1
    v_permlane16_swap_b32 v28, v60
    v_max_f32 v28, v28, v60
    v_mov_b32 v60, v28
    s_nop 1
    v_permlane32_swap_b32 v28, v60
    v_max_f32 v28, v28, v60
    v_mov_b32 v29, v28
    s_waitcnt vmcnt(0)
    v_sub_f32 v40, v48, v29
    v_exp_f32 v40, v40
    s_nop 0
    v_cvt_pk_bf16_f32 v42, v40, v40
    v_add_f32 v30, v30, v40
    v_and_b32 v32, v42, v3
    v_and_b32 v33, v42, v4
    v_and_b32_dpp v34, v42, v5 row_shr:4 row_mask:0xf bank_mask:0xf bound_ctrl:0
    v_and_b32_dpp v35, v42, v6 row_shr:4 row_mask:0xf bank_mask:0xf bound_ctrl:0
    v_and_b32_dpp v36, v42, v3 row_shl:4 row_mask:0xf bank_mask:0xf bound_ctrl:0
    v_and_b32_dpp v37, v42, v4 row_shl:4 row_mask:0xf bank_mask:0xf bound_ctrl:0
    v_and_b32 v38, v42, v5
    v_and_b32 v39, v42, v6
    v_mfma_f32_16x16x32_bf16 v[20:23], v[32:35], v[128:131], v[20:23]
    s_nop 0
    v_mfma_f32_16x16x32_bf16 v[20:23], v[36:39], v[132:135], v[20:23]
    v_sub_f32 v40, v49, v29
    v_exp_f32 v40, v40
    s_nop 0
    v_cvt_pk_bf16_f32 v42, v40, v40
    v_add_f32 v30, v30, v40
    v_and_b32 v32, v42, v3
    v_and_b32 v33, v42, v4
    v_and_b32_dpp v34, v42, v5 row_shr:4 row_mask:0xf bank_mask:0xf bound_ctrl:0
    v_and_b32_dpp v35, v42, v6 row_shr:4 row_mask:0xf bank_mask:0xf bound_ctrl:0
    v_and_b32_dpp v36, v42, v3 row_shl:4 row_mask:0xf bank_mask:0xf bound_ctrl:0
    v_and_b32_dpp v37, v42, v4 row_shl:4 row_mask:0xf bank_mask:0xf bound_ctrl:0
    v_and_b32 v38, v42, v5
    v_and_b32 v39, v42, v6
    v_mfma_f32_16x16x32_bf16 v[20:23], v[32:35], v[136:139], v[20:23]
    s_nop 0
    v_mfma_f32_16x16x32_bf16 v[20:23], v[36:39], v[140:143], v[20:23]
    v_sub_f32 v40, v50, v29
    v_exp_f32 v40, v40
    s_nop 0
    v_cvt_pk_bf16_f32 v42, v40, v40
    v_add_f32 v30, v30, v40
    v_and_b32 v32, v42, v3
    v_and_b32 v33, v42, v4
    v_and_b32_dpp v34, v42, v5 row_shr:4 row_mask:0xf bank_mask:0xf bound_ctrl:0
    v_and_b32_dpp v35, v42, v6 row_shr:4 row_mask:0xf bank_mask:0xf bound_ctrl:0
    v_and_b32_dpp v36, v42, v3 row_shl:4 row_mask:0xf bank_mask:0xf bound_ctrl:0
    v_and_b32_dpp v37, v42, v4 row_shl:4 row_mask:0xf bank_mask:0xf bound_ctrl:0
    v_and_b32 v38, v42, v5
    v_and_b32 v39, v42, v6
    v_mfma_f32_16x16x32_bf16 v[20:23], v[32:35], v[144:147], v[20:23]
    s_nop 0
    v_mfma_f32_16x16x32_bf16 v[20:23], v[36:39], v[148:151], v[20:23]
    v_sub_f32 v40, v51, v29
    v_exp_f32 v40, v40
    s_nop 0
    v_cvt_pk_bf16_f32 v42, v40, v40
    v_add_f32 v30, v30, v40
    v_and_b32 v32, v42, v3
    v_and_b32 v33, v42, v4
    v_and_b32_dpp v34, v42, v5 row_shr:4 row_mask:0xf bank_mask:0xf bound_ctrl:0
    v_and_b32_dpp v35, v42, v6 row_shr:4 row_mask:0xf bank_mask:0xf bound_ctrl:0
    v_and_b32_dpp v36, v42, v3 row_shl:4 row_mask:0xf bank_mask:0xf bound_ctrl:0
    v_and_b32_dpp v37, v42, v4 row_shl:4 row_mask:0xf bank_mask:0xf bound_ctrl:0
    v_and_b32 v38, v42, v5
    v_and_b32 v39, v42, v6
    v_mfma_f32_16x16x32_bf16 v[20:23], v[32:35], v[152:155], v[20:23]
    s_nop 0
    v_mfma_f32_16x16x32_bf16 v[20:23], v[36:39], v[156:159], v[20:23]
    v_sub_f32 v40, v52, v29
    v_exp_f32 v40, v40
    s_nop 0
    v_cvt_pk_bf16_f32 v42, v40, v40
    v_add_f32 v30, v30, v40
    v_and_b32 v32, v42, v3
    v_and_b32 v33, v42, v4
    v_and_b32_dpp v34, v42, v5 row_shr:4 row_mask:0xf bank_mask:0xf bound_ctrl:0
    v_and_b32_dpp v35, v42, v6 row_shr:4 row_mask:0xf bank_mask:0xf bound_ctrl:0
    v_and_b32_dpp v36, v42, v3 row_shl:4 row_mask:0xf bank_mask:0xf bound_ctrl:0
    v_and_b32_dpp v37, v42, v4 row_shl:4 row_mask:0xf bank_mask:0xf bound_ctrl:0
    v_and_b32 v38, v42, v5
    v_and_b32 v39, v42, v6
    v_mfma_f32_16x16x32_bf16 v[20:23], v[32:35], v[160:163], v[20:23]
    s_nop 0
    v_mfma_f32_16x16x32_bf16 v[20:23], v[36:39], v[164:167], v[20:23]
    v_sub_f32 v40, v53, v29
    v_exp_f32 v40, v40
    s_nop 0
    v_cvt_pk_bf16_f32 v42, v40, v40
    v_add_f32 v30, v30, v40
    v_and_b32 v32, v42, v3
    v_and_b32 v33, v42, v4
    v_and_b32_dpp v34, v42, v5 row_shr:4 row_mask:0xf bank_mask:0xf bound_ctrl:0
    v_and_b32_dpp v35, v42, v6 row_shr:4 row_mask:0xf bank_mask:0xf bound_ctrl:0
    v_and_b32_dpp v36, v42, v3 row_shl:4 row_mask:0xf bank_mask:0xf bound_ctrl:0
    v_and_b32_dpp v37, v42, v4 row_shl:4 row_mask:0xf bank_mask:0xf bound_ctrl:0
    v_and_b32 v38, v42, v5
    v_and_b32 v39, v42, v6
    v_mfma_f32_16x16x32_bf16 v[20:23], v[32:35], v[168:171], v[20:23]
    s_nop 0
    v_mfma_f32_16x16x32_bf16 v[20:23], v[36:39], v[172:175], v[20:23]
    v_sub_f32 v40, v54, v29
    v_exp_f32 v40, v40
    s_nop 0
    v_cvt_pk_bf16_f32 v42, v40, v40
    v_add_f32 v30, v30, v40
    v_and_b32 v32, v42, v3
    v_and_b32 v33, v42, v4
    v_and_b32_dpp v34, v42, v5 row_shr:4 row_mask:0xf bank_mask:0xf bound_ctrl:0
    v_and_b32_dpp v35, v42, v6 row_shr:4 row_mask:0xf bank_mask:0xf bound_ctrl:0
    v_and_b32_dpp v36, v42, v3 row_shl:4 row_mask:0xf bank_mask:0xf bound_ctrl:0
    v_and_b32_dpp v37, v42, v4 row_shl:4 row_mask:0xf bank_mask:0xf bound_ctrl:0
    v_and_b32 v38, v42, v5
    v_and_b32 v39, v42, v6
    v_mfma_f32_16x16x32_bf16 v[20:23], v[32:35], v[176:179], v[20:23]
    s_nop 0
    v_mfma_f32_16x16x32_bf16 v[20:23], v[36:39], v[180:183], v[20:23]
    v_sub_f32 v40, v55, v29
    v_exp_f32 v40, v40
    s_nop 0
    v_cvt_pk_bf16_f32 v42, v40, v40
    v_add_f32 v30, v30, v40
    v_and_b32 v32, v42, v3
    v_and_b32 v33, v42, v4
    v_and_b32_dpp v34, v42, v5 row_shr:4 row_mask:0xf bank_mask:0xf bound_ctrl:0
    v_and_b32_dpp v35, v42, v6 row_shr:4 row_mask:0xf bank_mask:0xf bound_ctrl:0
    v_and_b32_dpp v36, v42, v3 row_shl:4 row_mask:0xf bank_mask:0xf bound_ctrl:0
    v_and_b32_dpp v37, v42, v4 row_shl:4 row_mask:0xf bank_mask:0xf bound_ctrl:0
    v_and_b32 v38, v42, v5
    v_and_b32 v39, v42, v6
    v_mfma_f32_16x16x32_bf16 v[20:23], v[32:35], v[184:187], v[20:23]
    s_nop 0
    v_mfma_f32_16x16x32_bf16 v[20:23], v[36:39], v[188:191], v[20:23]
    s_nop 1
    v_add_f32_dpp v30, v30, v30 row_half_mirror row_mask:0xf bank_mask:0xf
    v_mov_b32 v60, v30
    s_nop 1
    v_permlane16_swap_b32 v30, v60
    v_add_f32 v30, v30, v60
    v_mov_b32 v60, v30
    s_nop 1
    v_permlane32_swap_b32 v30, v60
    v_add_f32 v30, v30, v60
    s_lshl_b32 s46, s32, 4
    s_add_u32 s46, s46, 704
    v_and_b32 v61, 8, v0
    v_add_u32 v61, s46, v61
    ds_write2_b32 v61, v29, v30 offset0:0 offset1:1
    s_lshl_b32 s46, s32, 10
    v_lshl_add_u32 v60, v0, 4, s46
    ds_write_b128 v60, v[20:23] offset:8192
    v_mov_b32 v60, 0
    v_mov_b32 v61, 1
    s_mov_b64 exec, 1
    ds_add_u32 v60, v61 offset:12
    s_mov_b64 exec, -1
    v_mov_b32 v11, 0
    s_cmp_eq_u32 s32, 0
    s_cbranch_scc0 L_h_nof
    s_lshl_b32 s48, s30, 8
    s_add_u32 s48, s48, 180224
    v_and_b32 v13, 15, v0
    v_lshl_add_u32 v13, v13, 2, s48
    global_load_dword v13, v13, s[28:29] nt
    s_waitcnt vmcnt(0)
    s_getreg_b32 s49, hwreg(HW_REG_XCC_ID, 0, 4)
    s_lshl_b32 s49, s49, 28
    s_and_b32 s48, s33, 0xfffffff
    s_or_b32 s48, s48, s49
    v_cmp_ne_u32 vcc, s48, v13
    s_nop 0
    s_cmp_eq_u64 vcc, 0
    s_cselect_b32 s55, 1, 0
    v_mov_b32 v19, s55
    ds_write_b32 v11, v19 offset:20
    s_mov_b32 s62, s55
L_wk:
    s_sleep 4
    ds_read_b32 v62, v11 offset:12
    s_waitcnt lgkmcnt(0)
    v_cmp_gt_u32 vcc, 8, v62
    s_cbranch_vccnz L_wk
    v_and_b32 v60, 1, v0
    v_lshlrev_b32 v60, 3, v60
    v_and_b32 v61, 2, v0
    v_lshl_add_u32 v10, v61, 5, v60
    ds_read_b64 v[32:33], v10 offset:640
    ds_read_b64 v[34:35], v10 offset:656
    ds_read_b64 v[36:37], v10 offset:672
    ds_read_b64 v[38:39], v10 offset:688
    s_lshl_b32 s48, s2, 8
    s_add_u32 s48, s48, 196608
    v_lshl_add_u32 v60, v0, 4, s48
    v_mov_b32 v53, s33
    v_mov_b32 v55, s33
    s_waitcnt lgkmcnt(0)
    v_max3_f32 v52, v32, v34, v36
    v_max_f32 v52, v52, v38
    v_sub_f32 v32, v32, v52
    v_sub_f32 v34, v34, v52
    v_sub_f32 v36, v36, v52
    v_sub_f32 v38, v38, v52
    v_exp_f32 v32, v32
    v_exp_f32 v34, v34
    v_exp_f32 v36, v36
    v_exp_f32 v38, v38
    v_mul_f32 v54, v33, v32
    v_fmac_f32 v54, v35, v34
    v_fmac_f32 v54, v37, v36
    v_fmac_f32 v54, v39, v38
    s_mov_b64 exec, 0xff
    s_cmp_eq_u32 s55, 0
    s_cbranch_scc1 L_farm
    global_store_dwordx4 v60, v[52:55], s[28:29]
    s_branch L_sentm
L_farm:
    global_store_dwordx4 v60, v[52:55], s[28:29] sc1
L_sentm:
    s_mov_b64 exec, -1
    s_lshl_b32 s48, s30, 8
    s_add_u32 s48, s48, 196608
    v_lshrrev_b32 v8, 2, v0
    v_lshlrev_b32 v8, 12, v8
    v_and_b32 v9, 3, v0
    v_lshl_add_u32 v8, v9, 4, v8
    v_add_u32 v8, s48, v8
    s_mov_b32 s46, 1048576
L_wm:
    s_sleep 4
    ds_read_b32 v62, v11 offset:24
    s_waitcnt lgkmcnt(0)
    v_cmp_gt_u32 vcc, 76, v62
    s_cbranch_vccnz L_wm
L_mlpoll:
    s_cmp_eq_u32 s55, 0
    s_cbranch_scc1 L_farn
    global_load_dwordx4 v[16:19], v8, s[28:29] nt
    s_branch L_sentn
L_farn:
    global_load_dwordx4 v[16:19], v8, s[28:29] sc1
L_sentn:
    s_mov_b32 s55, 0
    s_sub_u32 s46, s46, 1
    s_cbranch_scc1 L_mlgot
    s_waitcnt vmcnt(0)
    v_xor_b32 v40, s33, v17
    v_bitop3_b32 v40, v19, v40, s33 bitop3:0xde
    v_cmp_ne_u32 vcc, 0, v40
    s_cbranch_vccz L_mlgot
    s_sleep 32
    s_branch L_mlpoll
L_mlgot:
    s_waitcnt vmcnt(0)
    s_mov_b32 s55, s62
    v_and_b32 v61, 12, v0
    v_lshl_add_u32 v10, v61, 2, v10
    ds_read_b32 v12, v10 offset:640
    v_mov_b32 v20, v16
    s_nop 1
    v_max_f32_dpp v20, v20, v20 row_ror:4 row_mask:0xf bank_mask:0xf
    s_nop 1
    v_max_f32_dpp v20, v20, v20 row_ror:8 row_mask:0xf bank_mask:0xf
    v_mov_b32 v60, v20
    s_nop 1
    v_permlane16_swap_b32 v20, v60
    v_max_f32 v20, v20, v60
    v_mov_b32 v60, v20
    s_nop 1
    v_permlane32_swap_b32 v20, v60
    v_max_f32 v20, v20, v60
    v_sub_f32 v16, v16, v20
    v_exp_f32 v16, v16
    s_nop 0
    v_mul_f32 v17, v18, v16
    s_nop 1
    v_add_f32_dpp v17, v17, v17 row_ror:4 row_mask:0xf bank_mask:0xf
    s_nop 1
    v_add_f32_dpp v17, v17, v17 row_ror:8 row_mask:0xf bank_mask:0xf
    v_mov_b32 v60, v17
    s_nop 1
    v_permlane16_swap_b32 v17, v60
    v_add_f32 v17, v17, v60
    v_mov_b32 v60, v17
    s_nop 1
    v_permlane32_swap_b32 v17, v60
    v_add_f32 v17, v17, v60
    v_rcp_f32 v17, v17
    s_waitcnt lgkmcnt(0)
    v_sub_f32 v12, v12, v20
    v_exp_f32 v12, v12
    v_and_b32 v10, 15, v0
    v_lshlrev_b32 v10, 2, v10
    v_mul_f32 v12, v12, v17
    ds_write_b32 v10, v12 offset:768
    s_lshl_b32 s48, s30, 14
    s_lshl_b32 s49, s31, 10
    s_add_u32 s48, s48, s49
    s_add_u32 s48, s48, 524288
    v_lshrrev_b32 v57, 5, v0
    v_lshlrev_b32 v58, 2, v57
    v_and_b32 v56, 15, v0
    v_lshlrev_b32 v56, 5, v56
    v_lshl_add_u32 v56, v57, 9, v56
    v_and_b32 v60, 16, v0
    v_add3_u32 v56, v56, v60, s48
    ds_read_b32 v32, v58 offset:776
    ds_read_b32 v33, v58 offset:792
    ds_read_b32 v34, v58 offset:808
    ds_read_b32 v35, v58 offset:824
    ds_read_b128 v[12:15], v2 offset:8192
    ds_read_b128 v[16:19], v2 offset:9216
    ds_read_b128 v[20:23], v2 offset:10240
    ds_read_b128 v[24:27], v2 offset:11264
    s_waitcnt lgkmcnt(0)
    v_mul_f32 v44, v12, v32
    v_mul_f32 v45, v13, v32
    v_mul_f32 v46, v14, v32
    v_mul_f32 v47, v15, v32
    v_fmac_f32 v44, v16, v33
    v_fmac_f32 v45, v17, v33
    v_fmac_f32 v46, v18, v33
    v_fmac_f32 v47, v19, v33
    v_fmac_f32 v44, v20, v34
    v_fmac_f32 v45, v21, v34
    v_fmac_f32 v46, v22, v34
    v_fmac_f32 v47, v23, v34
    v_fmac_f32 v44, v24, v35
    v_fmac_f32 v45, v25, v35
    v_fmac_f32 v46, v26, v35
    v_fmac_f32 v47, v27, v35
    v_and_or_b32 v44, v44, v59, s52
    v_and_or_b32 v45, v45, v59, s52
    v_and_or_b32 v46, v46, v59, s52
    v_and_or_b32 v47, v47, v59, s52
    s_cmp_eq_u32 s55, 0
    s_cbranch_scc1 L_farb
    global_store_dwordx4 v56, v[44:47], s[28:29]
    s_branch L_sentb
L_farb:
    global_store_dwordx4 v56, v[44:47], s[28:29] sc1
L_sentb:
    s_branch L_h_join
L_h_nof:
    s_cmp_eq_u32 s32, 1
    s_cbranch_scc0 L_h_join
    s_lshl_b32 s48, s30, 8
    s_add_u32 s48, s48, 180224
    v_and_b32 v13, 15, v0
    v_lshl_add_u32 v13, v13, 2, s48
    v_and_b32 v14, 16, v0
    v_lshlrev_b32 v14, 7, v14
    v_xor_b32 v13, v13, v14
    global_load_dword v13, v13, s[28:29] nt
    s_getreg_b32 s49, hwreg(HW_REG_XCC_ID, 0, 4)
    s_lshl_b32 s49, s49, 28
    s_and_b32 s48, s33, 0xfffffff
    s_or_b32 s48, s48, s49
    s_waitcnt vmcnt(0)
    v_cmp_ne_u32 vcc, s48, v13
    s_cbranch_vccnz L_h_join
    s_and_b32 s48, s2, 7
    s_lshl_b32 s48, s48, 8
    s_add_u32 s48, s48, 188416
    v_lshl_add_u32 v8, v0, 2, s48
    s_lshr_b32 s49, s2, 3
    s_lshl_b32 s49, s49, 2
    s_add_u32 s48, s48, s49
    v_mov_b32 v9, s48
    s_add_u32 s63, s49, 8
    s_lshl_b32 s48, s49, 9
    s_add_u32 s48, s48, 917504
    s_add_u32 s64, s28, s48
    s_addc_u32 s65, s29, 0
    s_lshl_b32 s48, s2, 8
    s_add_u32 s48, s48, 917504
    v_lshl_add_u32 v18, v0, 2, s48
    v_mov_b32 v19, s33
    s_lshl_b32 s57, s33, 8
    s_mov_b32 s60, s57
    s_mov_b32 s61, 8
    s_mov_b32 s68, 0xf0000000
    s_mov_b32 s69, 0
    s_getreg_b32 s62, hwreg(HW_REG_XCC_ID, 0, 1)
    s_cmp_eq_u32 s62, 0
    s_cselect_b32 s62, 17, 22
    s_mov_b32 s58, 416
L_wp:
    s_sleep 2
    ds_read_b32 v62, v11 offset:24
    s_waitcnt lgkmcnt(0)
    v_cmp_gt_u32 vcc, s61, v62
    s_cbranch_vccnz L_wp
    s_add_u32 s60, s60, 1
    v_mov_b32 v10, s60
    s_cmp_eq_u32 s61, s63
    s_cbranch_scc0 L_lf_ng
    s_load_dword s70, s[64:65], 0 glc
    s_load_dword s71, s[64:65], 256 glc
    s_load_dword s72, s[64:65], 512 glc
    s_load_dword s73, s[64:65], 768 glc
    s_load_dword s74, s[64:65], 1024 glc
    s_load_dword s75, s[64:65], 1280 glc
    s_load_dword s76, s[64:65], 1536 glc
    s_load_dword s77, s[64:65], 1792 glc
    s_mov_b32 exec_hi, 0
    global_store_dword v18, v19, s[28:29] sc1
    s_mov_b64 exec, -1
L_lf_ng:
    global_load_dword v12, v8, s[28:29] nt
    s_mov_b64 exec, 1
    global_store_dword v9, v10, s[28:29]
    s_mov_b64 exec, -1
    s_waitcnt vmcnt(1)
    v_subrev_u32 v14, s57, v12
    v_cmp_ge_u32 vcc, 3, v14
    v_subrev_u32 v12, s60, v12
    s_and_b32 s66, vcc_hi, s69
    v_cmp_gt_u32 vcc, 8, v14
    s_bcnt1_i32_b32 s66, s66
    s_and_b32 s67, vcc_hi, s69
    v_cmp_le_u32 vcc, 7, v14
    s_mul_i32 s66, s66, 2
    s_and_b32 s67, vcc_hi, s67
    v_cmp_gt_u32 vcc, 64, v12
    s_bcnt1_i32_b32 s67, s67
    s_mul_i32 s67, s67, 3
    s_bcnt1_i32_b32 s48, vcc_lo
    s_lshl_b64 s[68:69], s[68:69], 1
    s_sub_i32 s48, s48, s62
    s_sub_i32 s48, s48, s66
    s_add_i32 s48, s48, s67
    s_cmp_lt_u32 s61, 64
    s_cselect_b32 s49, 20, 12
    s_cselect_b32 s66, 560, s58
    s_mul_i32 s48, s48, s49
    s_add_i32 s48, s48, s66
    s_max_i32 s48, s48, 0
    s_min_i32 s48, s48, 768
    s_lshr_b32 s48, s48, 5
    v_mov_b32 v13, s48
    ds_write_b32 v11, v13 offset:16
    s_cmp_eq_u32 s61, s63
    s_cbranch_scc0 L_lf_nx
    s_waitcnt lgkmcnt(0)
    s_mov_b32 s49, 0
    s_cmp_eq_u32 s70, s33
    s_addc_u32 s49, s49, 0
    s_cmp_eq_u32 s71, s33
    s_addc_u32 s49, s49, 0
    s_cmp_eq_u32 s72, s33
    s_addc_u32 s49, s49, 0
    s_cmp_eq_u32 s73, s33
    s_addc_u32 s49, s49, 0
    s_cmp_eq_u32 s74, s33
    s_addc_u32 s49, s49, 0
    s_cmp_eq_u32 s75, s33
    s_addc_u32 s49, s49, 0
    s_cmp_eq_u32 s76, s33
    s_addc_u32 s49, s49, 0
    s_cmp_eq_u32 s77, s33
    s_addc_u32 s49, s49, 0
    s_min_u32 s49, s49, 7
    s_or_b32 s48, s57, s49
    v_mov_b32 v10, s48
    s_mov_b64 exec, 1
    global_store_dword v9, v10, s[28:29] offset:128
    s_mov_b64 exec, -1
L_lf_nx:
    s_add_u32 s61, s61, 4
    s_cmp_le_u32 s61, 116
    s_cbranch_scc1 L_wp
L_h_join:
    s_waitcnt lgkmcnt(0)
    s_barrier
    s_cmp_eq_u32 s56, 0
    s_cbranch_scc1 L_h_nox
    buffer_load_dwordx4 v[192:195], v249, s[84:87], s3 offen nt
    s_add_u32 s3, s3, 4608
    buffer_load_dwordx4 v[196:199], v249, s[84:87], s3 offen nt
    s_add_u32 s3, s3, 4608
    buffer_load_dwordx4 v[200:203], v249, s[84:87], s3 offen nt
    s_add_u32 s3, s3, 4608
    buffer_load_dwordx4 v[204:207], v249, s[84:87], s3 offen nt
    s_add_u32 s3, s3, 4608
    buffer_load_dwordx4 v[208:211], v249, s[84:87], s3 offen nt
    s_add_u32 s3, s3, 4608
    buffer_load_dwordx4 v[212:215], v249, s[84:87], s3 offen nt
    s_add_u32 s3, s3, 4608
    buffer_load_dwordx4 v[216:219], v249, s[84:87], s3 offen nt
    s_add_u32 s3, s3, 4608
    buffer_load_dwordx4 v[220:223], v249, s[84:87], s3 offen nt
L_h_nox:
    buffer_load_dwordx4 v[64:67], v249, s[84:87], s34 offen nt
    s_add_u32 s34, s34, 4608
    buffer_load_dwordx4 v[68:71], v249, s[84:87], s34 offen nt
    s_add_u32 s34, s34, 4608
    s_barrier
    s_mov_b32 s46, 1048575
L_s2poll:
    global_load_dwordx4 v[16:19], v253, s[28:29] offset:0 sc1
    global_load_dwordx4 v[20:23], v253, s[28:29] offset:1024 sc1
    global_load_dwordx4 v[24:27], v253, s[28:29] offset:2048 sc1
    global_load_dwordx4 v[28:31], v253, s[28:29] offset:3072 sc1
L_s2chk:
    s_cmp_eq_u32 s46, 1048575
    s_cbranch_scc0 L_s2w0
    buffer_load_dwordx4 v[72:75], v249, s[84:87], s34 offen nt
    s_add_u32 s34, s34, 4608
    buffer_load_dwordx4 v[76:79], v249, s[84:87], s34 offen nt
    s_add_u32 s34, s34, 4608
    buffer_load_dwordx4 v[80:83], v249, s[84:87], s34 offen nt
    s_add_u32 s34, s34, 4608
    buffer_load_dwordx4 v[84:87], v249, s[84:87], s34 offen nt
    s_add_u32 s34, s34, 4608
    buffer_load_dwordx4 v[88:91], v249, s[84:87], s34 offen nt
    s_add_u32 s34, s34, 4608
    buffer_load_dwordx4 v[92:95], v249, s[84:87], s34 offen nt
    s_waitcnt vmcnt(6)
    s_branch L_s2w1
L_s2w0:
    s_waitcnt vmcnt(0)
L_s2w1:
    s_sub_u32 s46, s46, 1
    s_cbranch_scc1 L_s2got
    v_xor_b32 v16, s52, v16
    v_xor_b32 v17, s52, v17
    v_xor_b32 v18, s52, v18
    v_xor_b32 v19, s52, v19
    v_xor_b32 v20, s52, v20
    v_xor_b32 v21, s52, v21
    v_xor_b32 v22, s52, v22
    v_xor_b32 v23, s52, v23
    v_xor_b32 v24, s52, v24
    v_xor_b32 v25, s52, v25
    v_xor_b32 v26, s52, v26
    v_xor_b32 v27, s52, v27
    v_xor_b32 v28, s52, v28
    v_xor_b32 v29, s52, v29
    v_xor_b32 v30, s52, v30
    v_xor_b32 v31, s52, v31
    v_or3_b32 v40, v16, v17, v18
    v_or3_b32 v40, v40, v19, v20
    v_or3_b32 v40, v40, v21, v22
    v_or3_b32 v40, v40, v23, v24
    v_or3_b32 v40, v40, v25, v26
    v_or3_b32 v40, v40, v27, v28
    v_or3_b32 v40, v40, v29, v30
    v_bitop3_b32 v40, v40, v59, v31 bitop3:0x32
    v_cmp_ne_u32 vcc, 0, v40
    s_cbranch_vccnz L_s2poll
L_s2got:
    v_pk_add_f32 v[16:17], v[16:17], v[24:25]
    v_pk_add_f32 v[18:19], v[18:19], v[26:27]
    v_pk_add_f32 v[20:21], v[20:21], v[28:29]
    v_pk_add_f32 v[22:23], v[22:23], v[30:31]
    v_pk_add_f32 v[16:17], v[16:17], v[20:21]
    v_pk_add_f32 v[18:19], v[18:19], v[22:23]
    s_nop 1
    v_permlane32_swap_b32 v16, v18
    v_permlane32_swap_b32 v17, v19
    v_pk_add_f32 v[16:17], v[16:17], v[18:19]
    s_nop 1
    v_permlane16_swap_b32 v16, v17
    v_add_f32 v16, v16, v17
    v_cvt_pk_bf16_f32 v16, v16, v16
    s_nop 1
    v_mov_b32_dpp v20, v16 quad_perm:[0,0,0,0] row_mask:0xf bank_mask:0xf
    v_mov_b32_dpp v21, v16 quad_perm:[1,1,1,1] row_mask:0xf bank_mask:0xf
    v_mov_b32_dpp v22, v16 quad_perm:[2,2,2,2] row_mask:0xf bank_mask:0xf
    v_mov_b32_dpp v23, v16 quad_perm:[3,3,3,3] row_mask:0xf bank_mask:0xf
L_wob:
    s_cmp_eq_u32 s56, 0
    s_cbranch_scc0 L_two
    v_and_b32 v32, v20, v3
    v_and_b32 v33, v20, v4
    v_and_b32_dpp v34, v20, v5 row_shr:4 row_mask:0xf bank_mask:0xf bound_ctrl:0
    v_and_b32_dpp v35, v20, v6 row_shr:4 row_mask:0xf bank_mask:0xf bound_ctrl:0
    v_and_b32 v36, v21, v3
    v_and_b32 v37, v21, v4
    v_and_b32_dpp v38, v21, v5 row_shr:4 row_mask:0xf bank_mask:0xf bound_ctrl:0
    v_and_b32_dpp v39, v21, v6 row_shr:4 row_mask:0xf bank_mask:0xf bound_ctrl:0
    v_mfma_f32_16x16x32_bf16 v[24:27], v[32:35], v[64:67], 0
    v_and_b32 v32, v22, v3
    v_and_b32 v33, v22, v4
    v_and_b32_dpp v34, v22, v5 row_shr:4 row_mask:0xf bank_mask:0xf bound_ctrl:0
    v_and_b32_dpp v35, v22, v6 row_shr:4 row_mask:0xf bank_mask:0xf bound_ctrl:0
    v_mfma_f32_16x16x32_bf16 v[24:27], v[36:39], v[68:71], v[24:27]
    v_and_b32 v36, v23, v3
    v_and_b32 v37, v23, v4
    v_and_b32_dpp v38, v23, v5 row_shr:4 row_mask:0xf bank_mask:0xf bound_ctrl:0
    v_and_b32_dpp v39, v23, v6 row_shr:4 row_mask:0xf bank_mask:0xf bound_ctrl:0
    s_waitcnt vmcnt(5)
    v_mfma_f32_16x16x32_bf16 v[24:27], v[32:35], v[72:75], v[24:27]
    v_and_b32_dpp v32, v20, v3 row_shl:4 row_mask:0xf bank_mask:0xf bound_ctrl:0
    v_and_b32_dpp v33, v20, v4 row_shl:4 row_mask:0xf bank_mask:0xf bound_ctrl:0
    v_and_b32 v34, v20, v5
    v_and_b32 v35, v20, v6
    s_waitcnt vmcnt(4)
    v_mfma_f32_16x16x32_bf16 v[24:27], v[36:39], v[76:79], v[24:27]
    v_and_b32_dpp v36, v21, v3 row_shl:4 row_mask:0xf bank_mask:0xf bound_ctrl:0
    v_and_b32_dpp v37, v21, v4 row_shl:4 row_mask:0xf bank_mask:0xf bound_ctrl:0
    v_and_b32 v38, v21, v5
    v_and_b32 v39, v21, v6
    s_waitcnt vmcnt(3)
    v_mfma_f32_16x16x32_bf16 v[24:27], v[32:35], v[80:83], v[24:27]
    v_and_b32_dpp v32, v22, v3 row_shl:4 row_mask:0xf bank_mask:0xf bound_ctrl:0
    v_and_b32_dpp v33, v22, v4 row_shl:4 row_mask:0xf bank_mask:0xf bound_ctrl:0
    v_and_b32 v34, v22, v5
    v_and_b32 v35, v22, v6
    s_waitcnt vmcnt(2)
    v_mfma_f32_16x16x32_bf16 v[24:27], v[36:39], v[84:87], v[24:27]
    v_and_b32_dpp v36, v23, v3 row_shl:4 row_mask:0xf bank_mask:0xf bound_ctrl:0
    v_and_b32_dpp v37, v23, v4 row_shl:4 row_mask:0xf bank_mask:0xf bound_ctrl:0
    v_and_b32 v38, v23, v5
    v_and_b32 v39, v23, v6
    s_waitcnt vmcnt(1)
    v_mfma_f32_16x16x32_bf16 v[24:27], v[32:35], v[88:91], v[24:27]
    s_nop 0
    s_waitcnt vmcnt(0)
    v_mfma_f32_16x16x32_bf16 v[24:27], v[36:39], v[92:95], v[24:27]
L_red:
    v_mov_b32 v60, 0
    v_mov_b32 v61, 1
    s_nop 3
    s_mov_b32 exec_lo, 0x00ff00ff
    s_mov_b32 exec_hi, 0xff00ff00
    ds_write_b128 v251, v[24:27] offset:2048
    s_mov_b64 exec, 1
    ds_add_rtn_u32 v62, v60, v61 offset:8
    s_mov_b64 exec, -1
    ds_read_b32 v40, v252 offset:2048
    ds_read_b32 v41, v252 offset:2304
    ds_read_b32 v42, v252 offset:2560
    ds_read_b32 v43, v252 offset:2816
    ds_read_b32 v44, v252 offset:3072
    ds_read_b32 v45, v252 offset:3328
    ds_read_b32 v46, v252 offset:3584
    ds_read_b32 v47, v252 offset:3840
    s_waitcnt lgkmcnt(8)
    v_readfirstlane_b32 s35, v62
    s_nop 0
    s_and_b32 s35, s35, 3
    s_cmp_eq_u32 s35, 3
    s_cbranch_scc0 L_unit_ret
    s_waitcnt lgkmcnt(4)
    v_pk_add_f32 v[40:41], v[40:41], v[42:43]
    s_waitcnt lgkmcnt(0)
    v_pk_add_f32 v[44:45], v[44:45], v[46:47]
    v_pk_add_f32 v[40:41], v[40:41], v[44:45]
    v_add_f32 v40, v40, v41
    v_and_or_b32 v40, v40, v59, s52
    global_store_dword v254, v40, s[28:29] sc1
L_unit_ret:
    s_cmp_lt_u32 s30, 9
    s_cbranch_scc0 L_hend
    s_cmp_ge_u32 s31, 14
    s_cbranch_scc0 L_hend
    s_sub_u32 s50, 15, s31
    s_mul_i32 s46, s50, 9
    s_add_u32 s46, s46, s30
    s_lshl_b32 s48, s46, 12
    s_lshl_b32 s49, s32, 6
    s_add_u32 s48, s48, s49
    s_add_u32 s48, s48, 786432
    v_lshrrev_b32 v8, 2, v0
    v_lshlrev_b32 v8, 8, v8
    v_and_b32 v9, 3, v0
    v_lshl_add_u32 v8, v9, 4, v8
    v_add_u32 v8, s48, v8
    s_lshl_b32 s48, s46, 7
    s_lshl_b32 s49, s32, 5
    s_add_u32 s48, s48, s49
    v_lshrrev_b32 v10, 5, v0
    v_lshlrev_b32 v10, 2, v10
    v_lshl_add_u32 v10, v9, 3, v10
    v_add_u32 v10, s48, v10
    s_mov_b32 s51, s46
    s_cmp_ge_u32 s46, 16
    s_mov_b32 s46, 1048576
    s_waitcnt lgkmcnt(0)
    s_cbranch_scc1 L_s3x
    global_load_dwordx4 v[64:67], v8, s[28:29] sc1
    global_load_dwordx4 v[68:71], v8, s[28:29] sc1
L_s3poll:
    global_load_dwordx4 v[72:75], v8, s[28:29] sc1
    s_waitcnt vmcnt(2)
    v_xor_b32 v16, s52, v64
    v_xor_b32 v17, s52, v65
    v_xor_b32 v18, s52, v66
    v_xor_b32 v19, s52, v67
    v_or3_b32 v40, v16, v17, v18
    v_bitop3_b32 v40, v40, v59, v19 bitop3:0x32
    v_cmp_ne_u32 vcc, 0, v40
    s_cbranch_vccz L_s3got
    s_sleep 1
    global_load_dwordx4 v[64:67], v8, s[28:29] sc1
    s_waitcnt vmcnt(2)
    v_xor_b32 v16, s52, v68
    v_xor_b32 v17, s52, v69
    v_xor_b32 v18, s52, v70
    v_xor_b32 v19, s52, v71
    v_or3_b32 v40, v16, v17, v18
    v_bitop3_b32 v40, v40, v59, v19 bitop3:0x32
    v_cmp_ne_u32 vcc, 0, v40
    s_cbranch_vccz L_s3got
    s_sleep 1
    global_load_dwordx4 v[68:71], v8, s[28:29] sc1
    s_waitcnt vmcnt(2)
    v_xor_b32 v16, s52, v72
    v_xor_b32 v17, s52, v73
    v_xor_b32 v18, s52, v74
    v_xor_b32 v19, s52, v75
    v_or3_b32 v40, v16, v17, v18
    v_bitop3_b32 v40, v40, v59, v19 bitop3:0x32
    v_cmp_ne_u32 vcc, 0, v40
    s_cbranch_vccz L_s3got
    s_sleep 1
    s_sub_u32 s46, s46, 1
    s_cbranch_scc0 L_s3poll
L_s3got:
    s_nop 0
    v_permlane32_swap_b32 v16, v18
    v_permlane32_swap_b32 v17, v19
    v_add_f32 v16, v16, v18
    v_add_f32 v17, v17, v19
    v_mov_b32 v18, v16
    v_mov_b32 v19, v17
    s_nop 0
    v_permlane16_swap_b32 v16, v18
    v_permlane16_swap_b32 v17, v19
    v_add_f32 v16, v16, v18
    v_add_f32 v17, v17, v19
    s_nop 0
    v_add_f32_dpp v16, v16, v16 row_ror:4 row_mask:0xf bank_mask:0xf
    v_add_f32_dpp v17, v17, v17 row_ror:4 row_mask:0xf bank_mask:0xf
    s_nop 0
    v_add_f32_dpp v16, v16, v16 row_ror:8 row_mask:0xf bank_mask:0xf
    v_add_f32_dpp v17, v17, v17 row_ror:8 row_mask:0xf bank_mask:0xf
    v_cvt_pk_bf16_f32 v16, v16, v17
    s_mov_b32 exec_lo, 15
    s_mov_b32 exec_hi, 15
    global_store_dword v10, v16, s[24:25]
    s_or_b32 s46, s30, s50
    s_or_b32 s46, s46, s32
    s_cbranch_scc1 L_noep
    s_mov_b64 exec, 1
    v_mov_b32 v16, s33
    v_mov_b32 v17, 0
    global_store_dword v17, v16, s[28:29]
L_noep:
L_hend:
    s_endpgm
L_s3x:
    s_lshl_b32 s48, s51, 14
    s_lshl_b32 s49, s32, 6
    s_add_u32 s48, s48, s49
    s_add_u32 s48, s48, 606208
    v_lshrrev_b32 v8, 2, v0
    v_lshlrev_b32 v8, 10, v8
    v_lshl_add_u32 v8, v9, 4, v8
    v_add_u32 v8, s48, v8
L_s3xpoll:
    global_load_dwordx4 v[16:19], v8, s[28:29] offset:0 sc1
    global_load_dwordx4 v[20:23], v8, s[28:29] offset:256 sc1
    global_load_dwordx4 v[24:27], v8, s[28:29] offset:512 sc1
    global_load_dwordx4 v[28:31], v8, s[28:29] offset:768 sc1
    s_sub_u32 s46, s46, 1
    s_cbranch_scc1 L_s3got
    s_waitcnt vmcnt(0)
    v_xor_b32 v16, s52, v16
    v_xor_b32 v17, s52, v17
    v_xor_b32 v18, s52, v18
    v_xor_b32 v19, s52, v19
    v_xor_b32 v20, s52, v20
    v_xor_b32 v21, s52, v21
    v_xor_b32 v22, s52, v22
    v_xor_b32 v23, s52, v23
    v_xor_b32 v24, s52, v24
    v_xor_b32 v25, s52, v25
    v_xor_b32 v26, s52, v26
    v_xor_b32 v27, s52, v27
    v_xor_b32 v28, s52, v28
    v_xor_b32 v29, s52, v29
    v_xor_b32 v30, s52, v30
    v_xor_b32 v31, s52, v31
    v_or3_b32 v40, v16, v17, v18
    v_or3_b32 v40, v40, v19, v20
    v_or3_b32 v40, v40, v21, v22
    v_or3_b32 v40, v40, v23, v24
    v_or3_b32 v40, v40, v25, v26
    v_or3_b32 v40, v40, v27, v28
    v_or3_b32 v40, v40, v29, v30
    v_bitop3_b32 v40, v40, v59, v31 bitop3:0x32
    v_cmp_ne_u32 vcc, 0, v40
    s_cbranch_vccnz L_s3xpoll
    v_pk_add_f32 v[16:17], v[16:17], v[24:25]
    v_pk_add_f32 v[18:19], v[18:19], v[26:27]
    v_pk_add_f32 v[20:21], v[20:21], v[28:29]
    v_pk_add_f32 v[22:23], v[22:23], v[30:31]
    v_pk_add_f32 v[16:17], v[16:17], v[20:21]
    v_pk_add_f32 v[18:19], v[18:19], v[22:23]
    s_branch L_s3got
L_two:
    v_and_b32 v32, v20, v3
    v_and_b32 v33, v20, v4
    v_and_b32_dpp v34, v20, v5 row_shr:4 row_mask:0xf bank_mask:0xf bound_ctrl:0
    v_and_b32_dpp v35, v20, v6 row_shr:4 row_mask:0xf bank_mask:0xf bound_ctrl:0
    v_and_b32 v36, v21, v3
    v_and_b32 v37, v21, v4
    v_and_b32_dpp v38, v21, v5 row_shr:4 row_mask:0xf bank_mask:0xf bound_ctrl:0
    v_and_b32_dpp v39, v21, v6 row_shr:4 row_mask:0xf bank_mask:0xf bound_ctrl:0
    v_mfma_f32_16x16x32_bf16 v[28:31], v[32:35], v[192:195], 0
    v_and_b32 v32, v22, v3
    v_and_b32 v33, v22, v4
    v_and_b32_dpp v34, v22, v5 row_shr:4 row_mask:0xf bank_mask:0xf bound_ctrl:0
    v_and_b32_dpp v35, v22, v6 row_shr:4 row_mask:0xf bank_mask:0xf bound_ctrl:0
    v_mfma_f32_16x16x32_bf16 v[28:31], v[36:39], v[196:199], v[28:31]
    v_and_b32 v36, v23, v3
    v_and_b32 v37, v23, v4
    v_and_b32_dpp v38, v23, v5 row_shr:4 row_mask:0xf bank_mask:0xf bound_ctrl:0
    v_and_b32_dpp v39, v23, v6 row_shr:4 row_mask:0xf bank_mask:0xf bound_ctrl:0
    v_mfma_f32_16x16x32_bf16 v[28:31], v[32:35], v[200:203], v[28:31]
    v_and_b32_dpp v32, v20, v3 row_shl:4 row_mask:0xf bank_mask:0xf bound_ctrl:0
    v_and_b32_dpp v33, v20, v4 row_shl:4 row_mask:0xf bank_mask:0xf bound_ctrl:0
    v_and_b32 v34, v20, v5
    v_and_b32 v35, v20, v6
    v_mfma_f32_16x16x32_bf16 v[28:31], v[36:39], v[204:207], v[28:31]
    v_and_b32_dpp v36, v21, v3 row_shl:4 row_mask:0xf bank_mask:0xf bound_ctrl:0
    v_and_b32_dpp v37, v21, v4 row_shl:4 row_mask:0xf bank_mask:0xf bound_ctrl:0
    v_and_b32 v38, v21, v5
    v_and_b32 v39, v21, v6
    v_mfma_f32_16x16x32_bf16 v[28:31], v[32:35], v[208:211], v[28:31]
    v_and_b32_dpp v32, v22, v3 row_shl:4 row_mask:0xf bank_mask:0xf bound_ctrl:0
    v_and_b32_dpp v33, v22, v4 row_shl:4 row_mask:0xf bank_mask:0xf bound_ctrl:0
    v_and_b32 v34, v22, v5
    v_and_b32 v35, v22, v6
    v_mfma_f32_16x16x32_bf16 v[28:31], v[36:39], v[212:215], v[28:31]
    v_and_b32_dpp v36, v23, v3 row_shl:4 row_mask:0xf bank_mask:0xf bound_ctrl:0
    v_and_b32_dpp v37, v23, v4 row_shl:4 row_mask:0xf bank_mask:0xf bound_ctrl:0
    v_and_b32 v38, v23, v5
    v_and_b32 v39, v23, v6
    v_mfma_f32_16x16x32_bf16 v[28:31], v[32:35], v[216:219], v[28:31]
    s_nop 0
    v_mfma_f32_16x16x32_bf16 v[28:31], v[36:39], v[220:223], v[28:31]
    s_nop 7
    v_permlane32_swap_b32 v28, v32
    v_permlane32_swap_b32 v29, v33
    v_permlane32_swap_b32 v30, v34
    v_permlane32_swap_b32 v31, v35
    v_add_f32_dpp v48, v32, v28 row_shl:8 row_mask:0xf bank_mask:0xf bound_ctrl:0
    v_add_f32_dpp v49, v33, v29 row_shl:8 row_mask:0xf bank_mask:0xf bound_ctrl:0
    v_add_f32_dpp v50, v34, v30 row_shl:8 row_mask:0xf bank_mask:0xf bound_ctrl:0
    v_add_f32_dpp v51, v35, v31 row_shl:8 row_mask:0xf bank_mask:0xf bound_ctrl:0
    v_and_or_b32 v48, v48, v59, s52
    v_and_or_b32 v49, v49, v59, s52
    v_and_or_b32 v50, v50, v59, s52
    v_and_or_b32 v51, v51, v59, s52
    s_mov_b64 exec, 0x00ff00ff
    global_store_dwordx4 v255, v[48:51], s[28:29] sc1
    s_mov_b64 exec, -1
    v_and_b32 v32, v20, v3
    v_and_b32 v33, v20, v4
    v_and_b32_dpp v34, v20, v5 row_shr:4 row_mask:0xf bank_mask:0xf bound_ctrl:0
    v_and_b32_dpp v35, v20, v6 row_shr:4 row_mask:0xf bank_mask:0xf bound_ctrl:0
    v_and_b32 v36, v21, v3
    v_and_b32 v37, v21, v4
    v_and_b32_dpp v38, v21, v5 row_shr:4 row_mask:0xf bank_mask:0xf bound_ctrl:0
    v_and_b32_dpp v39, v21, v6 row_shr:4 row_mask:0xf bank_mask:0xf bound_ctrl:0
    v_mfma_f32_16x16x32_bf16 v[24:27], v[32:35], v[64:67], 0
    v_and_b32 v32, v22, v3
    v_and_b32 v33, v22, v4
    v_and_b32_dpp v34, v22, v5 row_shr:4 row_mask:0xf bank_mask:0xf bound_ctrl:0
    v_and_b32_dpp v35, v22, v6 row_shr:4 row_mask:0xf bank_mask:0xf bound_ctrl:0
    v_mfma_f32_16x16x32_bf16 v[24:27], v[36:39], v[68:71], v[24:27]
    v_and_b32 v36, v23, v3
    v_and_b32 v37, v23, v4
    v_and_b32_dpp v38, v23, v5 row_shr:4 row_mask:0xf bank_mask:0xf bound_ctrl:0
    v_and_b32_dpp v39, v23, v6 row_shr:4 row_mask:0xf bank_mask:0xf bound_ctrl:0
    s_waitcnt vmcnt(6)
    v_mfma_f32_16x16x32_bf16 v[24:27], v[32:35], v[72:75], v[24:27]
    v_and_b32_dpp v32, v20, v3 row_shl:4 row_mask:0xf bank_mask:0xf bound_ctrl:0
    v_and_b32_dpp v33, v20, v4 row_shl:4 row_mask:0xf bank_mask:0xf bound_ctrl:0
    v_and_b32 v34, v20, v5
    v_and_b32 v35, v20, v6
    s_waitcnt vmcnt(5)
    v_mfma_f32_16x16x32_bf16 v[24:27], v[36:39], v[76:79], v[24:27]
    v_and_b32_dpp v36, v21, v3 row_shl:4 row_mask:0xf bank_mask:0xf bound_ctrl:0
    v_and_b32_dpp v37, v21, v4 row_shl:4 row_mask:0xf bank_mask:0xf bound_ctrl:0
    v_and_b32 v38, v21, v5
    v_and_b32 v39, v21, v6
    s_waitcnt vmcnt(4)
    v_mfma_f32_16x16x32_bf16 v[24:27], v[32:35], v[80:83], v[24:27]
    v_and_b32_dpp v32, v22, v3 row_shl:4 row_mask:0xf bank_mask:0xf bound_ctrl:0
    v_and_b32_dpp v33, v22, v4 row_shl:4 row_mask:0xf bank_mask:0xf bound_ctrl:0
    v_and_b32 v34, v22, v5
    v_and_b32 v35, v22, v6
    s_waitcnt vmcnt(3)
    v_mfma_f32_16x16x32_bf16 v[24:27], v[36:39], v[84:87], v[24:27]
    v_and_b32_dpp v36, v23, v3 row_shl:4 row_mask:0xf bank_mask:0xf bound_ctrl:0
    v_and_b32_dpp v37, v23, v4 row_shl:4 row_mask:0xf bank_mask:0xf bound_ctrl:0
    v_and_b32 v38, v23, v5
    v_and_b32 v39, v23, v6
    s_waitcnt vmcnt(2)
    v_mfma_f32_16x16x32_bf16 v[24:27], v[32:35], v[88:91], v[24:27]
    s_nop 0
    s_waitcnt vmcnt(1)
    v_mfma_f32_16x16x32_bf16 v[24:27], v[36:39], v[92:95], v[24:27]
    s_branch L_red
    s_endpgm
.section .rodata,"a"
.p2align 6
.amdhsa_kernel concat_heads__gqa_block_cached__sliding_block_cached__decode_kernel
  .amdhsa_next_free_vgpr 256
  .amdhsa_next_free_sgpr 96
  .amdhsa_accum_offset 256
  .amdhsa_group_segment_fixed_size 0
  .amdhsa_kernarg_size 104
  .amdhsa_user_sgpr_count 2
  .amdhsa_user_sgpr_kernarg_segment_ptr 1
  .amdhsa_system_sgpr_workgroup_id_x 1
  .amdhsa_float_denorm_mode_32 3
.end_amdhsa_kernel
```
